```python
import torch

def _softmax(x, axis=-1):
    return torch.softmax(x, dim=axis)
def _gelu(x):
    return torch.nn.functional.gelu(x, approximate="tanh")
def _silu(x):
    return torch.nn.functional.silu(x)
def _sigmoid(x):
    return torch.sigmoid(x)
def _layernorm(x, axis=-1, eps=1e-5):
    m = x.mean(dim=axis, keepdim=True)
    v = x.var(dim=axis, keepdim=True, unbiased=False)
    return (x - m) / torch.sqrt(v + eps)
def _scatter_add(tgt, idx, src, axis=0):
    return tgt.clone().index_add_(axis, idx, src)
def _segment_sum(src, seg, n):
    out = torch.zeros((n,) + src.shape[1:], dtype=src.dtype)
    return out.index_add_(0, seg, src)
def _pad(x, pw):
    flat = tuple(v for pair in reversed(pw) for v in pair)
    return torch.nn.functional.pad(x, flat)

kernel_name = 'concat_heads__gqa_block_cached__mha_block_cached__near_ridge'

def setup_inputs():

    _w = (lambda a: (lambda t: t.to(torch.bfloat16) if t.is_floating_point() else t)(torch.as_tensor(a)))
    def _A_setup():
        B, Sq, D = 32, 32, 1024
        Hq, Hkv, Sk, Dh = 32, 4, 512, 128
        assert Hq % Hkv == 0, (Hq, Hkv)
        return {
            "x": _w((lambda *s: torch.randn(*s, dtype=torch.bfloat16) * 0.8)(B, Sq, D)),
            "k_cache": _w((lambda *s: torch.randn(*s, dtype=torch.bfloat16) * 0.8)(B, Hkv, Sk, Dh)),
            "v_cache": _w((lambda *s: torch.randn(*s, dtype=torch.bfloat16) * 0.05)(B, Hkv, Sk, Dh)),
            "wq": _w((lambda *s: torch.randn(*s, dtype=torch.bfloat16) * 0.8)(D, Hq * Dh) * (D ** -0.5)),
            "wo": _w((lambda *s: torch.randn(*s, dtype=torch.bfloat16) * 0.05)(Hq * Dh, D) * ((Hq * Dh) ** -0.5)),
        }
    _A_in = _A_setup()

    def _B_setup():
        B, Sq, D = 32, 32, 1024
        H, Sk, Dh = 32, 512, 128
        return {
            "x": _w((lambda *s: torch.randn(*s, dtype=torch.bfloat16) * 0.8)(B, Sq, D)),
            "k_cache": _w((lambda *s: torch.randn(*s, dtype=torch.bfloat16) * 0.8)(B, H, Sk, Dh)),
            "v_cache": _w((lambda *s: torch.randn(*s, dtype=torch.bfloat16) * 0.05)(B, H, Sk, Dh)),
            "wq": _w((lambda *s: torch.randn(*s, dtype=torch.bfloat16) * 0.8)(D, H * Dh) * (D ** -0.5)),
            "wo": _w((lambda *s: torch.randn(*s, dtype=torch.bfloat16) * 0.05)(H * Dh, D) * ((H * Dh) ** -0.5)),
        }
    _B_in = _B_setup()

    return {
        "A_x": _A_in["x"],
        "A_k_cache": _A_in["k_cache"],
        "A_v_cache": _A_in["v_cache"],
        "A_wq": _A_in["wq"],
        "A_wo": _A_in["wo"],
        "B_x": _B_in["x"],
        "B_k_cache": _B_in["k_cache"],
        "B_v_cache": _B_in["v_cache"],
        "B_wq": _B_in["wq"],
        "B_wo": _B_in["wo"],
    }

def reference(A_x, A_k_cache, A_v_cache, A_wq, A_wo, B_x, B_k_cache, B_v_cache, B_wq, B_wo):
    def _A_ref(x, k_cache, v_cache, wq, wo):
        B, Sq, D = x.shape
        Hq, Dh = 32, 128
        Hkv = k_cache.shape[1]
        rep = Hq // Hkv
        q = (lambda x, *d: x.permute(*d))((x @ wq).reshape(B, Sq, Hq, Dh), 0, 2, 1, 3)
        k = (lambda x, n, axis: torch.repeat_interleave(x, n, dim=axis))(k_cache, rep, axis=1)
        v = (lambda x, n, axis: torch.repeat_interleave(x, n, dim=axis))(v_cache, rep, axis=1)
        scores = torch.einsum("bhqd,bhkd->bhqk", q, k) * (Dh ** -0.5)
        p = _softmax(scores, axis=-1)
        o = torch.einsum("bhqk,bhkd->bhqd", p, v)
        return (lambda x, *d: x.permute(*d))(o, 0, 2, 1, 3).reshape(B, Sq, Hq * Dh) @ wo

    def _B_ref(x, k_cache, v_cache, wq, wo):
        B, Sq, D = x.shape
        H, Dh = 32, 128
        q = (lambda x, *d: x.permute(*d))((x @ wq).reshape(B, Sq, H, Dh), 0, 2, 1, 3)
        scores = torch.einsum("bhqd,bhkd->bhqk", q, k_cache) * (Dh ** -0.5)
        p = _softmax(scores, axis=-1)
        o = torch.einsum("bhqk,bhkd->bhqd", p, v_cache)
        return (lambda x, *d: x.permute(*d))(o, 0, 2, 1, 3).reshape(B, Sq, H * Dh) @ wo

    a = _A_ref(A_x, A_k_cache, A_v_cache, A_wq, A_wo)
    b = _B_ref(B_x, B_k_cache, B_v_cache, B_wq, B_wo)
    return torch.concatenate([a, b], axis=-1)
```

```asm
; @launch grid=(256,1,1) block=(512,1,1) lds=163840
.amdgcn_target "amdgcn-amd-amdhsa--gfx950"
.text
.globl concat_heads__gqa_block_cached__mha_block_cached__near_ridge_kernel
.p2align 8
.type concat_heads__gqa_block_cached__mha_block_cached__near_ridge_kernel,@function
concat_heads__gqa_block_cached__mha_block_cached__near_ridge_kernel:
    s_cmp_ge_u32 s2, 256
    s_cbranch_scc1 concat_heads__gqa_block_cached__mha_block_cached__near_ridge_kernel_done
    s_load_dwordx8 s[48:55], s[0:1], 0
    s_load_dwordx8 s[56:63], s[0:1], 40
    s_load_dwordx2 s[64:65], s[0:1], 96
    s_load_dwordx2 s[66:67], s[0:1], 88
    v_lshrrev_b32 v2, 6, v0
    v_and_b32 v0, 63, v0
    v_readfirstlane_b32 s79, v2
    s_nop 2
    s_lshr_b32 s5, s79, 2
    s_and_b32 s4, s79, 3
    s_mul_i32 s100, s5, 81920
    s_lshl_b32 s101, s4, 13
    s_and_b32 s28, s2, 7
    s_bfe_u32 s29, s2, 0x50003
    s_lshr_b32 s6, s28, 1
    s_lshl_b32 s6, s6, 3
    s_and_b32 s30, s29, 7
    s_add_u32 s6, s6, s30
    s_and_b32 s7, s28, 1
    s_lshl_b32 s7, s7, 2
    s_lshr_b32 s30, s29, 3
    s_add_u32 s7, s7, s30
    s_mov_b32 s81, s28
    s_add_u32 s86, s6, s7
    s_and_b32 s86, s86, 3
    v_lshlrev_b32 v1, 4, v0
    v_add_u32 v30, s100, v1
    s_lshl_b32 s30, s5, 6
    s_add_u32 s30, s30, 77824
    v_mov_b32 v29, s30
    s_mov_b32 s78, 0
    v_lshrrev_b32 v2, 4, v0
    v_and_b32 v3, 15, v0
    v_lshlrev_b32 v4, 8, v2
    v_add_u32 v5, 0, v2
    v_xor_b32 v5, v5, v3
    v_lshlrev_b32 v5, 4, v5
    v_add_u32 v6, v5, v4
    v_add_u32 v5, 4, v2
    v_xor_b32 v5, v5, v3
    v_lshlrev_b32 v5, 4, v5
    v_add_u32 v7, v5, v4
    v_add_u32 v5, 8, v2
    v_xor_b32 v5, v5, v3
    v_lshlrev_b32 v5, 4, v5
    v_add_u32 v8, v5, v4
    v_add_u32 v5, 12, v2
    v_xor_b32 v5, v5, v3
    v_lshlrev_b32 v5, 4, v5
    v_add_u32 v9, v5, v4
    v_lshlrev_b32 v5, 2, v2
    v_xor_b32 v5, v5, v3
    v_lshlrev_b32 v5, 4, v5
    v_add_u32 v10, v5, v4
    v_lshlrev_b32 v4, 13, v2
    v_add_u32 v224, v5, v4
    v_add_u32 v225, 31744, v224
    v_add_u32 v226, 63488, v224
    v_add_u32 v227, 95232, v224
    v_lshrrev_b32 v3, 3, v0
    v_and_b32 v4, 7, v0
    v_add_u32 v5, 0, v2
    v_and_b32 v5, 7, v5
    v_xor_b32 v5, v5, v4
    v_lshlrev_b32 v5, 4, v5
    v_lshlrev_b32 v228, 11, v3
    v_add_u32 v228, v228, v5
    v_add_u32 v5, 4, v2
    v_and_b32 v5, 7, v5
    v_xor_b32 v5, v5, v4
    v_lshlrev_b32 v5, 4, v5
    v_lshlrev_b32 v229, 11, v3
    v_add_u32 v229, v229, v5
    v_add_u32 v229, 15360, v229
    v_add_u32 v5, 8, v2
    v_and_b32 v5, 7, v5
    v_xor_b32 v5, v5, v4
    v_lshlrev_b32 v5, 4, v5
    v_lshlrev_b32 v230, 11, v3
    v_add_u32 v230, v230, v5
    v_add_u32 v230, 30720, v230
    v_add_u32 v5, 12, v2
    v_and_b32 v5, 7, v5
    v_xor_b32 v5, v5, v4
    v_lshlrev_b32 v5, 4, v5
    v_lshlrev_b32 v231, 11, v3
    v_add_u32 v231, v231, v5
    v_add_u32 v231, 46080, v231
    s_waitcnt lgkmcnt(0)
    s_cmp_eq_u32 s5, 0
    s_cselect_b32 s8, s56, s48
    s_cselect_b32 s9, s57, s49
    s_cselect_b32 s16, s58, s50
    s_cselect_b32 s17, s59, s51
    s_cselect_b32 s20, s60, s52
    s_cselect_b32 s21, s61, s53
    s_cselect_b32 s12, s62, s54
    s_cselect_b32 s13, s63, s55
    s_mov_b32 s28, 134217728
    s_cselect_b32 s18, s28, 16777216
    s_mov_b32 s22, s18
    s_and_b32 s9, s9, 0xffff
    s_mov_b32 s11, 0x20000
    s_and_b32 s17, s17, 0xffff
    s_mov_b32 s19, 0x20000
    s_and_b32 s21, s21, 0xffff
    s_mov_b32 s23, 0x20000
    s_and_b32 s13, s13, 0xffff
    s_mov_b32 s15, 0x20000
    s_mov_b32 s10, 2097152
    s_mov_b32 s14, 8388608
    s_mov_b32 s82, s66
    s_mov_b32 s83, s67
    s_mov_b32 s88, s66
    s_and_b32 s89, s67, 0xffff
    s_mov_b32 s90, 256
    s_mov_b32 s91, 0x20000
    s_mov_b32 s24, s64
    s_and_b32 s25, s65, 0xffff
    s_mov_b32 s26, 67108864
    s_mov_b32 s27, 0x20000
    s_lshl_b32 s28, s4, 3
    s_add_u32 s3, s28, s7
    s_lshl_b32 s32, s3, 16
    s_lshl_b32 s33, s4, 17
    s_lshl_b32 s28, s6, 8
    s_add_u32 s33, s33, s28
    v_and_b32 v2, 31, v0
    v_lshrrev_b32 v3, 5, v0
    v_bfe_u32 v4, v0, 1, 3
    v_xor_b32 v4, v4, v3
    v_lshlrev_b32 v4, 4, v4
    v_lshlrev_b32 v5, 7, v2
    v_add_u32 v236, v4, v5
    s_add_u32 s28, s101, 32768
    s_add_u32 s28, s28, s100
    v_add_u32 v236, s28, v236
    v_xor_b32 v237, 32, v236
    v_xor_b32 v238, 64, v236
    v_xor_b32 v239, 96, v236
    v_and_b32 v4, 15, v0
    v_xor_b32 v4, v4, v3
    v_lshlrev_b32 v4, 4, v4
    v_lshlrev_b32 v5, 8, v2
    v_add_u32 v11, v4, v5
    s_add_u32 s28, s101, s100
    v_add_u32 v11, s28, v11
    v_xor_b32 v12, 32, v11
    v_xor_b32 v13, 64, v11
    v_xor_b32 v14, 96, v11
    v_xor_b32 v15, 128, v11
    v_xor_b32 v16, 160, v11
    v_xor_b32 v17, 192, v11
    v_xor_b32 v18, 224, v11
    v_bfe_u32 v2, v0, 2, 2
    v_lshlrev_b32 v4, 6, v2
    v_bfe_u32 v5, v0, 4, 1
    v_lshlrev_b32 v5, 5, v5
    v_add_u32 v4, v4, v5
    v_and_b32 v5, 1, v0
    v_lshlrev_b32 v5, 4, v5
    v_add_u32 v4, v4, v5
    v_bfe_u32 v5, v0, 1, 1
    v_lshlrev_b32 v5, 3, v5
    v_add_u32 v4, v4, v5
    v_lshlrev_b32 v5, 3, v3
    v_add_u32 v5, v5, v2
    v_lshlrev_b32 v5, 8, v5
    v_add_u32 v232, v4, v5
    v_add_u32 v232, s100, v232
    v_lshlrev_b32 v5, 2, v3
    v_add_u32 v5, v5, v2
    v_lshlrev_b32 v5, 8, v5
    v_add_u32 v19, v4, v5
    v_xor_b32 v233, 64, v232
    v_xor_b32 v234, 128, v232
    v_xor_b32 v235, 192, v232
    s_add_u32 s28, s101, s100
    v_add_u32 v4, s28, v19
    s_add_u32 s28, s4, 0
    s_and_b32 s28, s28, 3
    s_lshl_b32 s28, s28, 6
    v_xor_b32 v19, s28, v4
    s_add_u32 s28, s4, 1
    s_and_b32 s28, s28, 3
    s_lshl_b32 s28, s28, 6
    v_xor_b32 v20, s28, v4
    s_add_u32 s28, s4, 2
    s_and_b32 s28, s28, 3
    s_lshl_b32 s28, s28, 6
    v_xor_b32 v21, s28, v4
    s_add_u32 s28, s4, 3
    s_and_b32 s28, s28, 3
    s_lshl_b32 s28, s28, 6
    v_xor_b32 v22, s28, v4
    s_add_u32 s41, s101, s100
    s_add_u32 s42, s41, 32768
    s_mov_b32 s40, 0x3e0293ee
    s_and_b32 s30, s6, 3
    s_lshl_b32 s30, s30, 3
    s_add_u32 s84, s30, s7
    s_lshr_b32 s85, s6, 2
    s_lshl_b32 s28, s7, 5
    s_add_u32 s28, s28, s6
    s_lshl_b32 s29, s84, 2
    s_lshr_b32 s30, s6, 3
    s_add_u32 s29, s29, s30
    s_cmp_eq_u32 s5, 0
    s_cselect_b32 s38, s28, s29
    s_lshl_b32 s38, s38, 17
    s_add_u32 s38, s38, s101
    s_mov_b32 s43, 33554432
    s_lshr_b32 s30, s6, 4
    v_mov_b32 v2, 0
    s_lshl_b32 s28, s7, 1
    s_add_u32 s28, s28, s30
    s_add_u32 s28, s28, 16
    s_lshl_b32 s28, s28, 8
    s_add_u32 s28, s28, 55574528
    buffer_load_dword v250, v2, s[24:27], s28 offen sc1
    s_lshl_b32 s28, s7, 1
    s_add_u32 s28, s28, s30
    s_lshl_b32 s28, s28, 8
    s_add_u32 s28, s28, 55574528
    buffer_load_dword v251, v2, s[24:27], s28 offen sc1
    s_lshr_b32 s44, s81, 2
    s_lshl_b32 s44, s44, 4
    s_bfe_u32 s30, s81, 0x10001
    s_bfe_u32 s45, s2, 0x30005
    s_and_b32 s29, s81, 1
    s_lshl_b32 s29, s29, 2
    s_bfe_u32 s31, s2, 0x20003
    s_add_u32 s29, s29, s31
    s_lshl_b32 s28, s45, 1
    s_add_u32 s28, s28, s30
    s_add_u32 s28, s28, s44
    s_lshl_b32 s28, s28, 8
    s_add_u32 s28, s28, 55574528
    buffer_load_dword v252, v2, s[24:27], s28 offen sc1
    s_cmp_eq_u32 s5, 0
    s_cbranch_scc1 concat_heads__gqa_block_cached__mha_block_cached__near_ridge_kernel_startb
    s_barrier
    s_barrier
    s_barrier
    s_barrier
    s_barrier
    s_barrier
    s_barrier
    s_barrier
    s_barrier
    s_barrier
    s_barrier
    s_barrier
    s_barrier
    s_barrier
    s_barrier
    s_barrier
    s_barrier
    v_mov_b32 v5, 0
    ds_write_b32 v29, v5
    s_waitcnt lgkmcnt(0)
    s_barrier
    s_lshl_b32 s92, s85, 3
    s_add_u32 s92, s92, s7
    s_lshl_b32 s92, s92, 8
    s_add_u32 s92, s92, 50331648
    v_mov_b32 v2, 0
    buffer_load_dword v31, v2, s[24:27], s92 offen sc0 sc1
    s_branch concat_heads__gqa_block_cached__mha_block_cached__near_ridge_kernel_q
concat_heads__gqa_block_cached__mha_block_cached__near_ridge_kernel_startb:
concat_heads__gqa_block_cached__mha_block_cached__near_ridge_kernel_q:
    s_mov_b32 s34, 65536
    s_mov_b32 s35, 65536
    s_mov_b32 s80, 0
    s_mov_b32 s36, 0
    s_add_u32 s29, s80, 1
    s_sub_u32 s29, s29, s86
    s_and_b32 s29, s29, 3
    s_cmp_eq_u32 s29, 0
    s_cselect_b32 s28, 1, 0
    s_cmp_eq_u32 s29, 1
    s_cselect_b32 s28, -1, s28
    s_add_u32 s87, s80, s28
    s_cmp_lt_u32 s87, 16
    s_cselect_b32 s87, s87, s80
    s_lshl_b32 s28, s4, 12
    s_add_u32 s28, s28, s100
    s_add_u32 m0, s34, s28
    s_lshl_b32 s29, s87, 19
    s_add_u32 s29, s29, s33
    buffer_load_dwordx4 v224, s[12:15], s29 offen offset:0  lds
    buffer_load_dwordx4 v225, s[12:15], s29 offen offset:1024  lds
    buffer_load_dwordx4 v226, s[12:15], s29 offen offset:2048  lds
    buffer_load_dwordx4 v227, s[12:15], s29 offen offset:3072  lds
    s_cmp_eq_u32 s34, 65536
    s_cselect_b32 s28, 0, 65536
    s_cmp_eq_u32 s34, 0
    s_cselect_b32 s34, 16384, s28
    s_add_u32 s80, s80, 1
    s_add_u32 m0, s42, 0
    s_lshl_b32 s29, s87, 7
    s_add_u32 s29, s29, s32
    buffer_load_dwordx4 v228, s[8:11], s29 offen offset:0  lds
    buffer_load_dwordx4 v229, s[8:11], s29 offen offset:1024  lds
    buffer_load_dwordx4 v230, s[8:11], s29 offen offset:2048  lds
    buffer_load_dwordx4 v231, s[8:11], s29 offen offset:3072  lds
    s_add_u32 s29, s80, 1
    s_sub_u32 s29, s29, s86
    s_and_b32 s29, s29, 3
    s_cmp_eq_u32 s29, 0
    s_cselect_b32 s28, 1, 0
    s_cmp_eq_u32 s29, 1
    s_cselect_b32 s28, -1, s28
    s_add_u32 s87, s80, s28
    s_cmp_lt_u32 s87, 16
    s_cselect_b32 s87, s87, s80
    s_lshl_b32 s28, s4, 12
    s_add_u32 s28, s28, s100
    s_add_u32 m0, s34, s28
    s_lshl_b32 s29, s87, 19
    s_add_u32 s29, s29, s33
    buffer_load_dwordx4 v224, s[12:15], s29 offen offset:0  lds
    buffer_load_dwordx4 v225, s[12:15], s29 offen offset:1024  lds
    buffer_load_dwordx4 v226, s[12:15], s29 offen offset:2048  lds
    buffer_load_dwordx4 v227, s[12:15], s29 offen offset:3072  lds
    s_cmp_eq_u32 s34, 65536
    s_cselect_b32 s28, 0, 65536
    s_cmp_eq_u32 s34, 0
    s_cselect_b32 s34, 16384, s28
    s_add_u32 s80, s80, 1
    s_add_u32 m0, s42, 4096
    s_lshl_b32 s29, s87, 7
    s_add_u32 s29, s29, s32
    buffer_load_dwordx4 v228, s[8:11], s29 offen offset:0  lds
    buffer_load_dwordx4 v229, s[8:11], s29 offen offset:1024  lds
    buffer_load_dwordx4 v230, s[8:11], s29 offen offset:2048  lds
    buffer_load_dwordx4 v231, s[8:11], s29 offen offset:3072  lds
    s_add_u32 s29, s80, 1
    s_sub_u32 s29, s29, s86
    s_and_b32 s29, s29, 3
    s_cmp_eq_u32 s29, 0
    s_cselect_b32 s28, 1, 0
    s_cmp_eq_u32 s29, 1
    s_cselect_b32 s28, -1, s28
    s_add_u32 s87, s80, s28
    s_cmp_lt_u32 s87, 16
    s_cselect_b32 s87, s87, s80
    s_lshl_b32 s28, s4, 12
    s_add_u32 s28, s28, s100
    s_add_u32 m0, s34, s28
    s_lshl_b32 s29, s87, 19
    s_add_u32 s29, s29, s33
    buffer_load_dwordx4 v224, s[12:15], s29 offen offset:0  lds
    buffer_load_dwordx4 v225, s[12:15], s29 offen offset:1024  lds
    buffer_load_dwordx4 v226, s[12:15], s29 offen offset:2048  lds
    buffer_load_dwordx4 v227, s[12:15], s29 offen offset:3072  lds
    s_cmp_eq_u32 s34, 65536
    s_cselect_b32 s28, 0, 65536
    s_cmp_eq_u32 s34, 0
    s_cselect_b32 s34, 16384, s28
    s_add_u32 s80, s80, 1
    v_mov_b32 v96, 0
    v_mov_b32 v97, 0
    v_mov_b32 v98, 0
    v_mov_b32 v99, 0
    v_mov_b32 v100, 0
    v_mov_b32 v101, 0
    v_mov_b32 v102, 0
    v_mov_b32 v103, 0
    v_mov_b32 v104, 0
    v_mov_b32 v105, 0
    v_mov_b32 v106, 0
    v_mov_b32 v107, 0
    v_mov_b32 v108, 0
    v_mov_b32 v109, 0
    v_mov_b32 v110, 0
    v_mov_b32 v111, 0
    v_mov_b32 v112, 0
    v_mov_b32 v113, 0
    v_mov_b32 v114, 0
    v_mov_b32 v115, 0
    v_mov_b32 v116, 0
    v_mov_b32 v117, 0
    v_mov_b32 v118, 0
    v_mov_b32 v119, 0
    v_mov_b32 v120, 0
    v_mov_b32 v121, 0
    v_mov_b32 v122, 0
    v_mov_b32 v123, 0
    v_mov_b32 v124, 0
    v_mov_b32 v125, 0
    v_mov_b32 v126, 0
    v_mov_b32 v127, 0
    v_mov_b32 v128, 0
    v_mov_b32 v129, 0
    v_mov_b32 v130, 0
    v_mov_b32 v131, 0
    v_mov_b32 v132, 0
    v_mov_b32 v133, 0
    v_mov_b32 v134, 0
    v_mov_b32 v135, 0
    v_mov_b32 v136, 0
    v_mov_b32 v137, 0
    v_mov_b32 v138, 0
    v_mov_b32 v139, 0
    v_mov_b32 v140, 0
    v_mov_b32 v141, 0
    v_mov_b32 v142, 0
    v_mov_b32 v143, 0
    v_mov_b32 v144, 0
    v_mov_b32 v145, 0
    v_mov_b32 v146, 0
    v_mov_b32 v147, 0
    v_mov_b32 v148, 0
    v_mov_b32 v149, 0
    v_mov_b32 v150, 0
    v_mov_b32 v151, 0
    v_mov_b32 v152, 0
    v_mov_b32 v153, 0
    v_mov_b32 v154, 0
    v_mov_b32 v155, 0
    v_mov_b32 v156, 0
    v_mov_b32 v157, 0
    v_mov_b32 v158, 0
    v_mov_b32 v159, 0
    v_add_u32 v240, s35, v232
    v_add_u32 v241, s35, v233
    v_add_u32 v242, s35, v234
    v_add_u32 v243, s35, v235
    s_cmp_eq_u32 s35, 65536
    s_cselect_b32 s28, 0, 65536
    s_cmp_eq_u32 s35, 0
    s_cselect_b32 s35, 16384, s28
    s_waitcnt vmcnt(12)
    s_cmp_lg_u32 s5, 0
    s_cbranch_scc1 qp1_g
    s_barrier
    s_branch qp1_d
qp1_g:
    s_add_u32 s78, s78, 1
    s_waitcnt lgkmcnt(0)
    v_mov_b32 v5, 1
    s_mov_b64 exec, 1
    ds_add_u32 v29, v5
    s_mov_b64 exec, -1
gb2:
    ds_read_b32 v5, v29
    s_waitcnt lgkmcnt(0)
    v_readfirstlane_b32 s31, v5
    s_lshl_b32 s30, s78, 2
    s_nop 1
    s_cmp_ge_u32 s31, s30
    s_cbranch_scc1 gb2_ok
    s_sleep 0
    s_branch gb2
gb2_ok:
qp1_d:
    ds_read_b128 v[64:67], v236 offset:0
    ds_read_b128 v[68:71], v237 offset:0
    ds_read_b128 v[72:75], v238 offset:0
    ds_read_b128 v[76:79], v239 offset:0
    ds_read_b64_tr_b16 v[160:161], v240 offset:0
    ds_read_b64_tr_b16 v[162:163], v240 offset:1024
    ds_read_b64_tr_b16 v[164:165], v241 offset:0
    ds_read_b64_tr_b16 v[166:167], v241 offset:1024
    ds_read_b64_tr_b16 v[168:169], v242 offset:0
    ds_read_b64_tr_b16 v[170:171], v242 offset:1024
    ds_read_b64_tr_b16 v[172:173], v243 offset:0
    ds_read_b64_tr_b16 v[174:175], v243 offset:1024
    ds_read_b64_tr_b16 v[176:177], v240 offset:4096
    ds_read_b64_tr_b16 v[178:179], v240 offset:5120
    ds_read_b64_tr_b16 v[180:181], v241 offset:4096
    ds_read_b64_tr_b16 v[182:183], v241 offset:5120
    ds_read_b64_tr_b16 v[184:185], v242 offset:4096
    ds_read_b64_tr_b16 v[186:187], v242 offset:5120
    ds_read_b64_tr_b16 v[188:189], v243 offset:4096
    ds_read_b64_tr_b16 v[190:191], v243 offset:5120
    s_mov_b32 s37, 0
concat_heads__gqa_block_cached__mha_block_cached__near_ridge_kernel_qloop:
    s_waitcnt lgkmcnt(8)
    v_mfma_f32_32x32x16_bf16 v[96:111], v[160:163], v[64:67], v[96:111]
    ds_read_b64_tr_b16 v[192:193], v240 offset:8192
    ds_read_b64_tr_b16 v[194:195], v240 offset:9216
    ds_read_b64_tr_b16 v[196:197], v241 offset:8192
    v_mfma_f32_32x32x16_bf16 v[112:127], v[164:167], v[64:67], v[112:127]
    ds_read_b64_tr_b16 v[198:199], v241 offset:9216
    ds_read_b64_tr_b16 v[200:201], v242 offset:8192
    ds_read_b64_tr_b16 v[202:203], v242 offset:9216
    v_mfma_f32_32x32x16_bf16 v[128:143], v[168:171], v[64:67], v[128:143]
    ds_read_b64_tr_b16 v[204:205], v243 offset:8192
    ds_read_b64_tr_b16 v[206:207], v243 offset:9216
    s_add_u32 m0, s42, 0
    v_mfma_f32_32x32x16_bf16 v[144:159], v[172:175], v[64:67], v[144:159]
    s_lshl_b32 s29, s87, 7
    s_add_u32 s29, s29, s32
    s_waitcnt lgkmcnt(8)
    v_mfma_f32_32x32x16_bf16 v[96:111], v[176:179], v[68:71], v[96:111]
    ds_read_b64_tr_b16 v[208:209], v240 offset:12288
    ds_read_b64_tr_b16 v[210:211], v240 offset:13312
    ds_read_b64_tr_b16 v[212:213], v241 offset:12288
    v_mfma_f32_32x32x16_bf16 v[112:127], v[180:183], v[68:71], v[112:127]
    ds_read_b64_tr_b16 v[214:215], v241 offset:13312
    ds_read_b64_tr_b16 v[216:217], v242 offset:12288
    ds_read_b64_tr_b16 v[218:219], v242 offset:13312
    v_mfma_f32_32x32x16_bf16 v[128:143], v[184:187], v[68:71], v[128:143]
    ds_read_b64_tr_b16 v[220:221], v243 offset:12288
    ds_read_b64_tr_b16 v[222:223], v243 offset:13312
    buffer_load_dwordx4 v228, s[8:11], s29 offen offset:0  lds
    v_mfma_f32_32x32x16_bf16 v[144:159], v[188:191], v[68:71], v[144:159]
    buffer_load_dwordx4 v229, s[8:11], s29 offen offset:1024  lds
    buffer_load_dwordx4 v230, s[8:11], s29 offen offset:2048  lds
    buffer_load_dwordx4 v231, s[8:11], s29 offen offset:3072  lds
    v_add_u32 v244, s35, v232
    v_add_u32 v245, s35, v233
    v_add_u32 v246, s35, v234
    v_add_u32 v247, s35, v235
    s_cmp_eq_u32 s35, 65536
    s_cselect_b32 s28, 0, 65536
    s_cmp_eq_u32 s35, 0
    s_cselect_b32 s35, 16384, s28
    s_waitcnt vmcnt(8) lgkmcnt(0)
    s_cmp_lg_u32 s5, 0
    s_cbranch_scc1 qp3_g
    s_barrier
    s_branch qp3_d
qp3_g:
    s_add_u32 s78, s78, 1
    s_waitcnt lgkmcnt(0)
    v_mov_b32 v5, 1
    s_mov_b64 exec, 1
    ds_add_u32 v29, v5
    s_mov_b64 exec, -1
gb4:
    ds_read_b32 v5, v29
    s_waitcnt lgkmcnt(0)
    v_readfirstlane_b32 s31, v5
    s_lshl_b32 s30, s78, 2
    s_nop 1
    s_cmp_ge_u32 s31, s30
    s_cbranch_scc1 gb4_ok
    s_sleep 0
    s_branch gb4
gb4_ok:
qp3_d:
    v_mfma_f32_32x32x16_bf16 v[96:111], v[192:195], v[72:75], v[96:111]
    ds_read_b128 v[80:83], v236 offset:4096
    ds_read_b128 v[84:87], v237 offset:4096
    ds_read_b128 v[88:91], v238 offset:4096
    ds_read_b128 v[92:95], v239 offset:4096
    ds_read_b64_tr_b16 v[160:161], v244 offset:0
    v_mfma_f32_32x32x16_bf16 v[112:127], v[196:199], v[72:75], v[112:127]
    ds_read_b64_tr_b16 v[162:163], v244 offset:1024
    ds_read_b64_tr_b16 v[164:165], v245 offset:0
    ds_read_b64_tr_b16 v[166:167], v245 offset:1024
    ds_read_b64_tr_b16 v[168:169], v246 offset:0
    ds_read_b64_tr_b16 v[170:171], v246 offset:1024
    v_mfma_f32_32x32x16_bf16 v[128:143], v[200:203], v[72:75], v[128:143]
    ds_read_b64_tr_b16 v[172:173], v247 offset:0
    ds_read_b64_tr_b16 v[174:175], v247 offset:1024
    s_add_u32 s29, s80, 1
    s_sub_u32 s29, s29, s86
    s_and_b32 s29, s29, 3
    v_mfma_f32_32x32x16_bf16 v[144:159], v[204:207], v[72:75], v[144:159]
    s_cmp_eq_u32 s29, 0
    s_cselect_b32 s28, 1, 0
    s_cmp_eq_u32 s29, 1
    s_cselect_b32 s28, -1, s28
    v_mfma_f32_32x32x16_bf16 v[96:111], v[208:211], v[76:79], v[96:111]
    ds_read_b64_tr_b16 v[176:177], v244 offset:4096
    ds_read_b64_tr_b16 v[178:179], v244 offset:5120
    ds_read_b64_tr_b16 v[180:181], v245 offset:4096
    ds_read_b64_tr_b16 v[182:183], v245 offset:5120
    ds_read_b64_tr_b16 v[184:185], v246 offset:4096
    ds_read_b64_tr_b16 v[186:187], v246 offset:5120
    ds_read_b64_tr_b16 v[188:189], v247 offset:4096
    v_mfma_f32_32x32x16_bf16 v[112:127], v[212:215], v[76:79], v[112:127]
    ds_read_b64_tr_b16 v[190:191], v247 offset:5120
    s_add_u32 s87, s80, s28
    s_cmp_lt_u32 s87, 16
    s_cselect_b32 s87, s87, s80
    s_lshl_b32 s28, s4, 12
    s_add_u32 s28, s28, s100
    s_add_u32 m0, s34, s28
    v_mfma_f32_32x32x16_bf16 v[128:143], v[216:219], v[76:79], v[128:143]
    s_lshl_b32 s29, s87, 19
    s_add_u32 s29, s29, s33
    buffer_load_dwordx4 v224, s[12:15], s29 offen offset:0  lds
    buffer_load_dwordx4 v225, s[12:15], s29 offen offset:1024  lds
    buffer_load_dwordx4 v226, s[12:15], s29 offen offset:2048  lds
    buffer_load_dwordx4 v227, s[12:15], s29 offen offset:3072  lds
    s_cmp_eq_u32 s34, 65536
    v_mfma_f32_32x32x16_bf16 v[144:159], v[220:223], v[76:79], v[144:159]
    s_cselect_b32 s28, 0, 65536
    s_cmp_eq_u32 s34, 0
    s_cselect_b32 s34, 16384, s28
    s_add_u32 s80, s80, 1
    s_waitcnt lgkmcnt(8)
    v_mfma_f32_32x32x16_bf16 v[96:111], v[160:163], v[80:83], v[96:111]
    ds_read_b64_tr_b16 v[192:193], v244 offset:8192
    ds_read_b64_tr_b16 v[194:195], v244 offset:9216
    ds_read_b64_tr_b16 v[196:197], v245 offset:8192
    v_mfma_f32_32x32x16_bf16 v[112:127], v[164:167], v[80:83], v[112:127]
    ds_read_b64_tr_b16 v[198:199], v245 offset:9216
    ds_read_b64_tr_b16 v[200:201], v246 offset:8192
    ds_read_b64_tr_b16 v[202:203], v246 offset:9216
    v_mfma_f32_32x32x16_bf16 v[128:143], v[168:171], v[80:83], v[128:143]
    ds_read_b64_tr_b16 v[204:205], v247 offset:8192
    ds_read_b64_tr_b16 v[206:207], v247 offset:9216
    s_add_u32 m0, s42, 4096
    v_mfma_f32_32x32x16_bf16 v[144:159], v[172:175], v[80:83], v[144:159]
    s_lshl_b32 s29, s87, 7
    s_add_u32 s29, s29, s32
    s_waitcnt lgkmcnt(8)
    v_mfma_f32_32x32x16_bf16 v[96:111], v[176:179], v[84:87], v[96:111]
    ds_read_b64_tr_b16 v[208:209], v244 offset:12288
    ds_read_b64_tr_b16 v[210:211], v244 offset:13312
    ds_read_b64_tr_b16 v[212:213], v245 offset:12288
    v_mfma_f32_32x32x16_bf16 v[112:127], v[180:183], v[84:87], v[112:127]
    ds_read_b64_tr_b16 v[214:215], v245 offset:13312
    ds_read_b64_tr_b16 v[216:217], v246 offset:12288
    ds_read_b64_tr_b16 v[218:219], v246 offset:13312
    v_mfma_f32_32x32x16_bf16 v[128:143], v[184:187], v[84:87], v[128:143]
    ds_read_b64_tr_b16 v[220:221], v247 offset:12288
    ds_read_b64_tr_b16 v[222:223], v247 offset:13312
    buffer_load_dwordx4 v228, s[8:11], s29 offen offset:0  lds
    v_mfma_f32_32x32x16_bf16 v[144:159], v[188:191], v[84:87], v[144:159]
    buffer_load_dwordx4 v229, s[8:11], s29 offen offset:1024  lds
    buffer_load_dwordx4 v230, s[8:11], s29 offen offset:2048  lds
    buffer_load_dwordx4 v231, s[8:11], s29 offen offset:3072  lds
    v_add_u32 v240, s35, v232
    v_add_u32 v241, s35, v233
    v_add_u32 v242, s35, v234
    v_add_u32 v243, s35, v235
    s_cmp_eq_u32 s35, 65536
    s_cselect_b32 s28, 0, 65536
    s_cmp_eq_u32 s35, 0
    s_cselect_b32 s35, 16384, s28
    s_waitcnt vmcnt(8) lgkmcnt(0)
    s_cmp_lg_u32 s5, 0
    s_cbranch_scc1 qp5_g
    s_barrier
    s_branch qp5_d
qp5_g:
    s_add_u32 s78, s78, 1
    s_waitcnt lgkmcnt(0)
    v_mov_b32 v5, 1
    s_mov_b64 exec, 1
    ds_add_u32 v29, v5
    s_mov_b64 exec, -1
gb6:
    ds_read_b32 v5, v29
    s_waitcnt lgkmcnt(0)
    v_readfirstlane_b32 s31, v5
    s_lshl_b32 s30, s78, 2
    s_nop 1
    s_cmp_ge_u32 s31, s30
    s_cbranch_scc1 gb6_ok
    s_sleep 0
    s_branch gb6
gb6_ok:
qp5_d:
    v_mfma_f32_32x32x16_bf16 v[96:111], v[192:195], v[88:91], v[96:111]
    ds_read_b128 v[64:67], v236 offset:0
    ds_read_b128 v[68:71], v237 offset:0
    ds_read_b128 v[72:75], v238 offset:0
    ds_read_b128 v[76:79], v239 offset:0
    ds_read_b64_tr_b16 v[160:161], v240 offset:0
    v_mfma_f32_32x32x16_bf16 v[112:127], v[196:199], v[88:91], v[112:127]
    ds_read_b64_tr_b16 v[162:163], v240 offset:1024
    ds_read_b64_tr_b16 v[164:165], v241 offset:0
    ds_read_b64_tr_b16 v[166:167], v241 offset:1024
    ds_read_b64_tr_b16 v[168:169], v242 offset:0
    ds_read_b64_tr_b16 v[170:171], v242 offset:1024
    v_mfma_f32_32x32x16_bf16 v[128:143], v[200:203], v[88:91], v[128:143]
    ds_read_b64_tr_b16 v[172:173], v243 offset:0
    ds_read_b64_tr_b16 v[174:175], v243 offset:1024
    s_add_u32 s29, s80, 1
    s_sub_u32 s29, s29, s86
    s_and_b32 s29, s29, 3
    v_mfma_f32_32x32x16_bf16 v[144:159], v[204:207], v[88:91], v[144:159]
    s_cmp_eq_u32 s29, 0
    s_cselect_b32 s28, 1, 0
    s_cmp_eq_u32 s29, 1
    s_cselect_b32 s28, -1, s28
    v_mfma_f32_32x32x16_bf16 v[96:111], v[208:211], v[92:95], v[96:111]
    ds_read_b64_tr_b16 v[176:177], v240 offset:4096
    ds_read_b64_tr_b16 v[178:179], v240 offset:5120
    ds_read_b64_tr_b16 v[180:181], v241 offset:4096
    ds_read_b64_tr_b16 v[182:183], v241 offset:5120
    ds_read_b64_tr_b16 v[184:185], v242 offset:4096
    ds_read_b64_tr_b16 v[186:187], v242 offset:5120
    ds_read_b64_tr_b16 v[188:189], v243 offset:4096
    v_mfma_f32_32x32x16_bf16 v[112:127], v[212:215], v[92:95], v[112:127]
    ds_read_b64_tr_b16 v[190:191], v243 offset:5120
    s_add_u32 s87, s80, s28
    s_cmp_lt_u32 s87, 16
    s_cselect_b32 s87, s87, s80
    s_lshl_b32 s28, s4, 12
    s_add_u32 s28, s28, s100
    s_add_u32 m0, s34, s28
    v_mfma_f32_32x32x16_bf16 v[128:143], v[216:219], v[92:95], v[128:143]
    s_lshl_b32 s29, s87, 19
    s_add_u32 s29, s29, s33
    buffer_load_dwordx4 v224, s[12:15], s29 offen offset:0  lds
    buffer_load_dwordx4 v225, s[12:15], s29 offen offset:1024  lds
    buffer_load_dwordx4 v226, s[12:15], s29 offen offset:2048  lds
    buffer_load_dwordx4 v227, s[12:15], s29 offen offset:3072  lds
    s_cmp_eq_u32 s34, 65536
    v_mfma_f32_32x32x16_bf16 v[144:159], v[220:223], v[92:95], v[144:159]
    s_cselect_b32 s28, 0, 65536
    s_cmp_eq_u32 s34, 0
    s_cselect_b32 s34, 16384, s28
    s_add_u32 s80, s80, 1
    s_add_u32 s37, s37, 2
    s_cmp_lt_u32 s37, 12
    s_cbranch_scc1 concat_heads__gqa_block_cached__mha_block_cached__near_ridge_kernel_qloop
    s_waitcnt lgkmcnt(8)
    v_mfma_f32_32x32x16_bf16 v[96:111], v[160:163], v[64:67], v[96:111]
    ds_read_b64_tr_b16 v[192:193], v240 offset:8192
    ds_read_b64_tr_b16 v[194:195], v240 offset:9216
    ds_read_b64_tr_b16 v[196:197], v241 offset:8192
    v_mfma_f32_32x32x16_bf16 v[112:127], v[164:167], v[64:67], v[112:127]
    ds_read_b64_tr_b16 v[198:199], v241 offset:9216
    ds_read_b64_tr_b16 v[200:201], v242 offset:8192
    ds_read_b64_tr_b16 v[202:203], v242 offset:9216
    v_mfma_f32_32x32x16_bf16 v[128:143], v[168:171], v[64:67], v[128:143]
    ds_read_b64_tr_b16 v[204:205], v243 offset:8192
    ds_read_b64_tr_b16 v[206:207], v243 offset:9216
    s_add_u32 m0, s42, 0
    v_mfma_f32_32x32x16_bf16 v[144:159], v[172:175], v[64:67], v[144:159]
    s_lshl_b32 s29, s87, 7
    s_add_u32 s29, s29, s32
    s_waitcnt lgkmcnt(8)
    v_mfma_f32_32x32x16_bf16 v[96:111], v[176:179], v[68:71], v[96:111]
    ds_read_b64_tr_b16 v[208:209], v240 offset:12288
    ds_read_b64_tr_b16 v[210:211], v240 offset:13312
    ds_read_b64_tr_b16 v[212:213], v241 offset:12288
    v_mfma_f32_32x32x16_bf16 v[112:127], v[180:183], v[68:71], v[112:127]
    ds_read_b64_tr_b16 v[214:215], v241 offset:13312
    ds_read_b64_tr_b16 v[216:217], v242 offset:12288
    ds_read_b64_tr_b16 v[218:219], v242 offset:13312
    v_mfma_f32_32x32x16_bf16 v[128:143], v[184:187], v[68:71], v[128:143]
    ds_read_b64_tr_b16 v[220:221], v243 offset:12288
    ds_read_b64_tr_b16 v[222:223], v243 offset:13312
    buffer_load_dwordx4 v228, s[8:11], s29 offen offset:0  lds
    v_mfma_f32_32x32x16_bf16 v[144:159], v[188:191], v[68:71], v[144:159]
    buffer_load_dwordx4 v229, s[8:11], s29 offen offset:1024  lds
    buffer_load_dwordx4 v230, s[8:11], s29 offen offset:2048  lds
    buffer_load_dwordx4 v231, s[8:11], s29 offen offset:3072  lds
    v_add_u32 v244, s35, v232
    v_add_u32 v245, s35, v233
    v_add_u32 v246, s35, v234
    v_add_u32 v247, s35, v235
    s_cmp_eq_u32 s35, 65536
    s_cselect_b32 s28, 0, 65536
    s_cmp_eq_u32 s35, 0
    s_cselect_b32 s35, 16384, s28
    s_waitcnt vmcnt(8) lgkmcnt(0)
    s_cmp_lg_u32 s5, 0
    s_cbranch_scc1 qp7_g
    s_barrier
    s_branch qp7_d
qp7_g:
    s_add_u32 s78, s78, 1
    s_waitcnt lgkmcnt(0)
    v_mov_b32 v5, 1
    s_mov_b64 exec, 1
    ds_add_u32 v29, v5
    s_mov_b64 exec, -1
gb8:
    ds_read_b32 v5, v29
    s_waitcnt lgkmcnt(0)
    v_readfirstlane_b32 s31, v5
    s_lshl_b32 s30, s78, 2
    s_nop 1
    s_cmp_ge_u32 s31, s30
    s_cbranch_scc1 gb8_ok
    s_sleep 0
    s_branch gb8
gb8_ok:
qp7_d:
    v_mfma_f32_32x32x16_bf16 v[96:111], v[192:195], v[72:75], v[96:111]
    ds_read_b128 v[80:83], v236 offset:4096
    ds_read_b128 v[84:87], v237 offset:4096
    ds_read_b128 v[88:91], v238 offset:4096
    ds_read_b128 v[92:95], v239 offset:4096
    ds_read_b64_tr_b16 v[160:161], v244 offset:0
    v_mfma_f32_32x32x16_bf16 v[112:127], v[196:199], v[72:75], v[112:127]
    ds_read_b64_tr_b16 v[162:163], v244 offset:1024
    ds_read_b64_tr_b16 v[164:165], v245 offset:0
    ds_read_b64_tr_b16 v[166:167], v245 offset:1024
    ds_read_b64_tr_b16 v[168:169], v246 offset:0
    ds_read_b64_tr_b16 v[170:171], v246 offset:1024
    v_mfma_f32_32x32x16_bf16 v[128:143], v[200:203], v[72:75], v[128:143]
    ds_read_b64_tr_b16 v[172:173], v247 offset:0
    ds_read_b64_tr_b16 v[174:175], v247 offset:1024
    s_add_u32 s29, s80, 1
    s_sub_u32 s29, s29, s86
    s_and_b32 s29, s29, 3
    v_mfma_f32_32x32x16_bf16 v[144:159], v[204:207], v[72:75], v[144:159]
    s_cmp_eq_u32 s29, 0
    s_cselect_b32 s28, 1, 0
    s_cmp_eq_u32 s29, 1
    s_cselect_b32 s28, -1, s28
    v_mfma_f32_32x32x16_bf16 v[96:111], v[208:211], v[76:79], v[96:111]
    ds_read_b64_tr_b16 v[176:177], v244 offset:4096
    ds_read_b64_tr_b16 v[178:179], v244 offset:5120
    ds_read_b64_tr_b16 v[180:181], v245 offset:4096
    ds_read_b64_tr_b16 v[182:183], v245 offset:5120
    ds_read_b64_tr_b16 v[184:185], v246 offset:4096
    ds_read_b64_tr_b16 v[186:187], v246 offset:5120
    ds_read_b64_tr_b16 v[188:189], v247 offset:4096
    v_mfma_f32_32x32x16_bf16 v[112:127], v[212:215], v[76:79], v[112:127]
    ds_read_b64_tr_b16 v[190:191], v247 offset:5120
    s_add_u32 s87, s80, s28
    s_cmp_lt_u32 s87, 16
    s_cselect_b32 s87, s87, s80
    s_lshl_b32 s28, s4, 12
    s_add_u32 s28, s28, s100
    s_add_u32 m0, s34, s28
    v_mfma_f32_32x32x16_bf16 v[128:143], v[216:219], v[76:79], v[128:143]
    s_lshl_b32 s29, s87, 19
    s_add_u32 s29, s29, s33
    buffer_load_dwordx4 v224, s[12:15], s29 offen offset:0  lds
    buffer_load_dwordx4 v225, s[12:15], s29 offen offset:1024  lds
    buffer_load_dwordx4 v226, s[12:15], s29 offen offset:2048  lds
    buffer_load_dwordx4 v227, s[12:15], s29 offen offset:3072  lds
    s_cmp_eq_u32 s34, 65536
    v_mfma_f32_32x32x16_bf16 v[144:159], v[220:223], v[76:79], v[144:159]
    s_cselect_b32 s28, 0, 65536
    s_cmp_eq_u32 s34, 0
    s_cselect_b32 s34, 16384, s28
    s_add_u32 s80, s80, 1
    s_waitcnt lgkmcnt(8)
    v_mfma_f32_32x32x16_bf16 v[96:111], v[160:163], v[80:83], v[96:111]
    ds_read_b64_tr_b16 v[192:193], v244 offset:8192
    ds_read_b64_tr_b16 v[194:195], v244 offset:9216
    ds_read_b64_tr_b16 v[196:197], v245 offset:8192
    v_mfma_f32_32x32x16_bf16 v[112:127], v[164:167], v[80:83], v[112:127]
    ds_read_b64_tr_b16 v[198:199], v245 offset:9216
    ds_read_b64_tr_b16 v[200:201], v246 offset:8192
    ds_read_b64_tr_b16 v[202:203], v246 offset:9216
    v_mfma_f32_32x32x16_bf16 v[128:143], v[168:171], v[80:83], v[128:143]
    ds_read_b64_tr_b16 v[204:205], v247 offset:8192
    ds_read_b64_tr_b16 v[206:207], v247 offset:9216
    s_add_u32 m0, s42, 4096
    v_mfma_f32_32x32x16_bf16 v[144:159], v[172:175], v[80:83], v[144:159]
    s_lshl_b32 s29, s87, 7
    s_add_u32 s29, s29, s32
    s_waitcnt lgkmcnt(8)
    v_mfma_f32_32x32x16_bf16 v[96:111], v[176:179], v[84:87], v[96:111]
    ds_read_b64_tr_b16 v[208:209], v244 offset:12288
    ds_read_b64_tr_b16 v[210:211], v244 offset:13312
    ds_read_b64_tr_b16 v[212:213], v245 offset:12288
    v_mfma_f32_32x32x16_bf16 v[112:127], v[180:183], v[84:87], v[112:127]
    ds_read_b64_tr_b16 v[214:215], v245 offset:13312
    ds_read_b64_tr_b16 v[216:217], v246 offset:12288
    ds_read_b64_tr_b16 v[218:219], v246 offset:13312
    v_mfma_f32_32x32x16_bf16 v[128:143], v[184:187], v[84:87], v[128:143]
    ds_read_b64_tr_b16 v[220:221], v247 offset:12288
    ds_read_b64_tr_b16 v[222:223], v247 offset:13312
    buffer_load_dwordx4 v228, s[8:11], s29 offen offset:0  lds
    v_mfma_f32_32x32x16_bf16 v[144:159], v[188:191], v[84:87], v[144:159]
    buffer_load_dwordx4 v229, s[8:11], s29 offen offset:1024  lds
    buffer_load_dwordx4 v230, s[8:11], s29 offen offset:2048  lds
    buffer_load_dwordx4 v231, s[8:11], s29 offen offset:3072  lds
    v_add_u32 v240, s35, v232
    v_add_u32 v241, s35, v233
    v_add_u32 v242, s35, v234
    v_add_u32 v243, s35, v235
    s_cmp_eq_u32 s35, 65536
    s_cselect_b32 s28, 0, 65536
    s_cmp_eq_u32 s35, 0
    s_cselect_b32 s35, 16384, s28
    s_waitcnt vmcnt(8) lgkmcnt(0)
    s_cmp_lg_u32 s5, 0
    s_cbranch_scc1 qp9_g
    s_barrier
    s_branch qp9_d
qp9_g:
    s_add_u32 s78, s78, 1
    s_waitcnt lgkmcnt(0)
    v_mov_b32 v5, 1
    s_mov_b64 exec, 1
    ds_add_u32 v29, v5
    s_mov_b64 exec, -1
gb10:
    ds_read_b32 v5, v29
    s_waitcnt lgkmcnt(0)
    v_readfirstlane_b32 s31, v5
    s_lshl_b32 s30, s78, 2
    s_nop 1
    s_cmp_ge_u32 s31, s30
    s_cbranch_scc1 gb10_ok
    s_sleep 0
    s_branch gb10
gb10_ok:
qp9_d:
    v_mfma_f32_32x32x16_bf16 v[96:111], v[192:195], v[88:91], v[96:111]
    ds_read_b128 v[64:67], v236 offset:0
    ds_read_b128 v[68:71], v237 offset:0
    ds_read_b128 v[72:75], v238 offset:0
    v_mfma_f32_32x32x16_bf16 v[112:127], v[196:199], v[88:91], v[112:127]
    ds_read_b128 v[76:79], v239 offset:0
    ds_read_b64_tr_b16 v[160:161], v240 offset:0
    ds_read_b64_tr_b16 v[162:163], v240 offset:1024
    v_mfma_f32_32x32x16_bf16 v[128:143], v[200:203], v[88:91], v[128:143]
    ds_read_b64_tr_b16 v[164:165], v241 offset:0
    ds_read_b64_tr_b16 v[166:167], v241 offset:1024
    ds_read_b64_tr_b16 v[168:169], v242 offset:0
    v_mfma_f32_32x32x16_bf16 v[144:159], v[204:207], v[88:91], v[144:159]
    ds_read_b64_tr_b16 v[170:171], v242 offset:1024
    ds_read_b64_tr_b16 v[172:173], v243 offset:0
    ds_read_b64_tr_b16 v[174:175], v243 offset:1024
    v_mfma_f32_32x32x16_bf16 v[96:111], v[208:211], v[92:95], v[96:111]
    ds_read_b64_tr_b16 v[176:177], v240 offset:4096
    ds_read_b64_tr_b16 v[178:179], v240 offset:5120
    v_mfma_f32_32x32x16_bf16 v[112:127], v[212:215], v[92:95], v[112:127]
    ds_read_b64_tr_b16 v[180:181], v241 offset:4096
    ds_read_b64_tr_b16 v[182:183], v241 offset:5120
    v_mfma_f32_32x32x16_bf16 v[128:143], v[216:219], v[92:95], v[128:143]
    ds_read_b64_tr_b16 v[184:185], v242 offset:4096
    ds_read_b64_tr_b16 v[186:187], v242 offset:5120
    v_mfma_f32_32x32x16_bf16 v[144:159], v[220:223], v[92:95], v[144:159]
    ds_read_b64_tr_b16 v[188:189], v243 offset:4096
    ds_read_b64_tr_b16 v[190:191], v243 offset:5120
    s_waitcnt lgkmcnt(8)
    v_mfma_f32_32x32x16_bf16 v[96:111], v[160:163], v[64:67], v[96:111]
    ds_read_b64_tr_b16 v[192:193], v240 offset:8192
    ds_read_b64_tr_b16 v[194:195], v240 offset:9216
    v_mfma_f32_32x32x16_bf16 v[112:127], v[164:167], v[64:67], v[112:127]
    ds_read_b64_tr_b16 v[196:197], v241 offset:8192
    ds_read_b64_tr_b16 v[198:199], v241 offset:9216
    v_mfma_f32_32x32x16_bf16 v[128:143], v[168:171], v[64:67], v[128:143]
    ds_read_b64_tr_b16 v[200:201], v242 offset:8192
    ds_read_b64_tr_b16 v[202:203], v242 offset:9216
    v_mfma_f32_32x32x16_bf16 v[144:159], v[172:175], v[64:67], v[144:159]
    ds_read_b64_tr_b16 v[204:205], v243 offset:8192
    ds_read_b64_tr_b16 v[206:207], v243 offset:9216
    s_waitcnt lgkmcnt(8)
    v_mfma_f32_32x32x16_bf16 v[96:111], v[176:179], v[68:71], v[96:111]
    ds_read_b64_tr_b16 v[208:209], v240 offset:12288
    ds_read_b64_tr_b16 v[210:211], v240 offset:13312
    v_mfma_f32_32x32x16_bf16 v[112:127], v[180:183], v[68:71], v[112:127]
    ds_read_b64_tr_b16 v[212:213], v241 offset:12288
    ds_read_b64_tr_b16 v[214:215], v241 offset:13312
    v_mfma_f32_32x32x16_bf16 v[128:143], v[184:187], v[68:71], v[128:143]
    ds_read_b64_tr_b16 v[216:217], v242 offset:12288
    ds_read_b64_tr_b16 v[218:219], v242 offset:13312
    v_mfma_f32_32x32x16_bf16 v[144:159], v[188:191], v[68:71], v[144:159]
    ds_read_b64_tr_b16 v[220:221], v243 offset:12288
    ds_read_b64_tr_b16 v[222:223], v243 offset:13312
    v_add_u32 v244, s35, v232
    v_add_u32 v245, s35, v233
    v_add_u32 v246, s35, v234
    v_add_u32 v247, s35, v235
    s_cmp_eq_u32 s35, 65536
    s_cselect_b32 s28, 0, 65536
    s_cmp_eq_u32 s35, 0
    s_cselect_b32 s35, 16384, s28
    s_waitcnt vmcnt(0) lgkmcnt(0)
    s_cmp_lg_u32 s5, 0
    s_cbranch_scc1 qp11_g
    s_barrier
    s_branch qp11_d
qp11_g:
    s_add_u32 s78, s78, 1
    s_waitcnt lgkmcnt(0)
    v_mov_b32 v5, 1
    s_mov_b64 exec, 1
    ds_add_u32 v29, v5
    s_mov_b64 exec, -1
gb12:
    ds_read_b32 v5, v29
    s_waitcnt lgkmcnt(0)
    v_readfirstlane_b32 s31, v5
    s_lshl_b32 s30, s78, 2
    s_nop 1
    s_cmp_ge_u32 s31, s30
    s_cbranch_scc1 gb12_ok
    s_sleep 0
    s_branch gb12
gb12_ok:
qp11_d:
    s_cmp_lg_u32 s5, 0
    s_cbranch_scc1 concat_heads__gqa_block_cached__mha_block_cached__near_ridge_kernel_hw
    s_mov_b32 m0, s41
    s_mov_b32 s28, s38
    buffer_load_dwordx4 v6, s[16:19], s28 offen offset:0 nt lds
    buffer_load_dwordx4 v7, s[16:19], s28 offen offset:1024 nt lds
    buffer_load_dwordx4 v8, s[16:19], s28 offen offset:2048 nt lds
    buffer_load_dwordx4 v9, s[16:19], s28 offen offset:3072 nt lds
    s_add_u32 m0, s41, 4096
    s_add_u32 s28, s28, 4096
    buffer_load_dwordx4 v6, s[16:19], s28 offen offset:0 nt lds
    buffer_load_dwordx4 v7, s[16:19], s28 offen offset:1024 nt lds
    buffer_load_dwordx4 v8, s[16:19], s28 offen offset:2048 nt lds
    buffer_load_dwordx4 v9, s[16:19], s28 offen offset:3072 nt lds
concat_heads__gqa_block_cached__mha_block_cached__near_ridge_kernel_hw:
    v_mfma_f32_32x32x16_bf16 v[96:111], v[192:195], v[72:75], v[96:111]
    ds_read_b128 v[80:83], v236 offset:4096
    ds_read_b128 v[84:87], v237 offset:4096
    ds_read_b128 v[88:91], v238 offset:4096
    v_mfma_f32_32x32x16_bf16 v[112:127], v[196:199], v[72:75], v[112:127]
    ds_read_b128 v[92:95], v239 offset:4096
    ds_read_b64_tr_b16 v[160:161], v244 offset:0
    ds_read_b64_tr_b16 v[162:163], v244 offset:1024
    v_mfma_f32_32x32x16_bf16 v[128:143], v[200:203], v[72:75], v[128:143]
    ds_read_b64_tr_b16 v[164:165], v245 offset:0
    ds_read_b64_tr_b16 v[166:167], v245 offset:1024
    ds_read_b64_tr_b16 v[168:169], v246 offset:0
    v_mfma_f32_32x32x16_bf16 v[144:159], v[204:207], v[72:75], v[144:159]
    ds_read_b64_tr_b16 v[170:171], v246 offset:1024
    ds_read_b64_tr_b16 v[172:173], v247 offset:0
    ds_read_b64_tr_b16 v[174:175], v247 offset:1024
    v_mfma_f32_32x32x16_bf16 v[96:111], v[208:211], v[76:79], v[96:111]
    ds_read_b64_tr_b16 v[176:177], v244 offset:4096
    ds_read_b64_tr_b16 v[178:179], v244 offset:5120
    v_mfma_f32_32x32x16_bf16 v[112:127], v[212:215], v[76:79], v[112:127]
    ds_read_b64_tr_b16 v[180:181], v245 offset:4096
    ds_read_b64_tr_b16 v[182:183], v245 offset:5120
    v_mfma_f32_32x32x16_bf16 v[128:143], v[216:219], v[76:79], v[128:143]
    ds_read_b64_tr_b16 v[184:185], v246 offset:4096
    ds_read_b64_tr_b16 v[186:187], v246 offset:5120
    v_mfma_f32_32x32x16_bf16 v[144:159], v[220:223], v[76:79], v[144:159]
    ds_read_b64_tr_b16 v[188:189], v247 offset:4096
    ds_read_b64_tr_b16 v[190:191], v247 offset:5120
    s_waitcnt lgkmcnt(8)
    v_mfma_f32_32x32x16_bf16 v[96:111], v[160:163], v[80:83], v[96:111]
    ds_read_b64_tr_b16 v[192:193], v244 offset:8192
    ds_read_b64_tr_b16 v[194:195], v244 offset:9216
    v_mfma_f32_32x32x16_bf16 v[112:127], v[164:167], v[80:83], v[112:127]
    ds_read_b64_tr_b16 v[196:197], v245 offset:8192
    ds_read_b64_tr_b16 v[198:199], v245 offset:9216
    v_mfma_f32_32x32x16_bf16 v[128:143], v[168:171], v[80:83], v[128:143]
    ds_read_b64_tr_b16 v[200:201], v246 offset:8192
    ds_read_b64_tr_b16 v[202:203], v246 offset:9216
    v_mfma_f32_32x32x16_bf16 v[144:159], v[172:175], v[80:83], v[144:159]
    ds_read_b64_tr_b16 v[204:205], v247 offset:8192
    ds_read_b64_tr_b16 v[206:207], v247 offset:9216
    s_waitcnt lgkmcnt(8)
    v_mfma_f32_32x32x16_bf16 v[96:111], v[176:179], v[84:87], v[96:111]
    ds_read_b64_tr_b16 v[208:209], v244 offset:12288
    ds_read_b64_tr_b16 v[210:211], v244 offset:13312
    v_mfma_f32_32x32x16_bf16 v[112:127], v[180:183], v[84:87], v[112:127]
    ds_read_b64_tr_b16 v[212:213], v245 offset:12288
    ds_read_b64_tr_b16 v[214:215], v245 offset:13312
    v_mfma_f32_32x32x16_bf16 v[128:143], v[184:187], v[84:87], v[128:143]
    ds_read_b64_tr_b16 v[216:217], v246 offset:12288
    ds_read_b64_tr_b16 v[218:219], v246 offset:13312
    v_mfma_f32_32x32x16_bf16 v[144:159], v[188:191], v[84:87], v[144:159]
    ds_read_b64_tr_b16 v[220:221], v247 offset:12288
    ds_read_b64_tr_b16 v[222:223], v247 offset:13312
    s_waitcnt lgkmcnt(8)
    v_mfma_f32_32x32x16_bf16 v[96:111], v[192:195], v[88:91], v[96:111]
    v_mfma_f32_32x32x16_bf16 v[112:127], v[196:199], v[88:91], v[112:127]
    v_mfma_f32_32x32x16_bf16 v[128:143], v[200:203], v[88:91], v[128:143]
    v_mfma_f32_32x32x16_bf16 v[144:159], v[204:207], v[88:91], v[144:159]
    s_waitcnt lgkmcnt(0)
    v_mfma_f32_32x32x16_bf16 v[96:111], v[208:211], v[92:95], v[96:111]
    v_mfma_f32_32x32x16_bf16 v[112:127], v[212:215], v[92:95], v[112:127]
    v_mfma_f32_32x32x16_bf16 v[128:143], v[216:219], v[92:95], v[128:143]
    v_mfma_f32_32x32x16_bf16 v[144:159], v[220:223], v[92:95], v[144:159]
    s_nop 11
    v_cvt_pk_bf16_f32 v32, v96, v97
    v_cvt_pk_bf16_f32 v33, v98, v99
    v_cvt_pk_bf16_f32 v34, v100, v101
    v_cvt_pk_bf16_f32 v35, v102, v103
    v_cvt_pk_bf16_f32 v36, v104, v105
    v_cvt_pk_bf16_f32 v37, v106, v107
    v_cvt_pk_bf16_f32 v38, v108, v109
    v_cvt_pk_bf16_f32 v39, v110, v111
    v_cvt_pk_bf16_f32 v40, v112, v113
    v_cvt_pk_bf16_f32 v41, v114, v115
    v_cvt_pk_bf16_f32 v42, v116, v117
    v_cvt_pk_bf16_f32 v43, v118, v119
    v_cvt_pk_bf16_f32 v44, v120, v121
    v_cvt_pk_bf16_f32 v45, v122, v123
    v_cvt_pk_bf16_f32 v46, v124, v125
    v_cvt_pk_bf16_f32 v47, v126, v127
    v_cvt_pk_bf16_f32 v48, v128, v129
    v_cvt_pk_bf16_f32 v49, v130, v131
    v_cvt_pk_bf16_f32 v50, v132, v133
    v_cvt_pk_bf16_f32 v51, v134, v135
    v_cvt_pk_bf16_f32 v52, v136, v137
    v_cvt_pk_bf16_f32 v53, v138, v139
    v_cvt_pk_bf16_f32 v54, v140, v141
    v_cvt_pk_bf16_f32 v55, v142, v143
    v_cvt_pk_bf16_f32 v56, v144, v145
    v_cvt_pk_bf16_f32 v57, v146, v147
    v_cvt_pk_bf16_f32 v58, v148, v149
    v_cvt_pk_bf16_f32 v59, v150, v151
    v_cvt_pk_bf16_f32 v60, v152, v153
    v_cvt_pk_bf16_f32 v61, v154, v155
    v_cvt_pk_bf16_f32 v62, v156, v157
    v_cvt_pk_bf16_f32 v63, v158, v159
    v_readfirstlane_b32 s82, v250
    v_readfirstlane_b32 s83, v251
    v_readfirstlane_b32 s75, v252
    s_nop 2
    s_mul_i32 s82, s82, 0x9e3779b1
    s_add_u32 s82, s82, 0x7f4a7c15
    s_mul_i32 s83, s83, 0x9e3779b1
    s_add_u32 s83, s83, 0x7f4a7c15
    s_mul_i32 s75, s75, 0x9e3779b1
    s_add_u32 s75, s75, 0x7f4a7c15
    s_cmp_lg_u32 s79, 0
    s_cbranch_scc1 concat_heads__gqa_block_cached__mha_block_cached__near_ridge_kernel_noack
    s_lshr_b32 s44, s81, 2
    s_lshl_b32 s44, s44, 4
    s_bfe_u32 s30, s81, 0x10001
    s_bfe_u32 s45, s2, 0x30005
    s_and_b32 s29, s81, 1
    s_lshl_b32 s29, s29, 2
    s_bfe_u32 s31, s2, 0x20003
    s_add_u32 s29, s29, s31
    s_lshl_b32 s28, s45, 1
    s_add_u32 s28, s28, s30
    s_add_u32 s28, s28, s44
    s_lshl_b32 s28, s28, 8
    s_add_u32 s28, s28, 55574528
    s_lshl_b32 s29, s29, 2
    s_add_u32 s28, s28, s29
    v_mov_b32 v2, 0
    v_mov_b32 v3, s75
    v_cmp_eq_u32 vcc, 0, v0
    s_and_saveexec_b64 s[30:31], vcc
    buffer_store_dword v3, v2, s[24:27], s28 offen offset:32 sc1
    s_mov_b64 exec, s[30:31]
concat_heads__gqa_block_cached__mha_block_cached__near_ridge_kernel_noack:
    s_cmp_lg_u32 s5, 0
    s_cbranch_scc1 concat_heads__gqa_block_cached__mha_block_cached__near_ridge_kernel_rolea
    s_barrier
    v_mov_b32 v5, 0
    ds_write_b32 v29, v5
    s_waitcnt lgkmcnt(0)
    s_barrier
    s_cmp_lg_u32 s5, 0
    s_cbranch_scc1 concat_heads__gqa_block_cached__mha_block_cached__near_ridge_kernel_rolea
    s_cmp_lg_u32 s4, 0
    s_cbranch_scc1 concat_heads__gqa_block_cached__mha_block_cached__near_ridge_kernel_q0_skip
    v_add_u32 v27, 65536, v30
    ds_write_b128 v27, v[32:35] offset:0
    ds_write_b128 v27, v[36:39] offset:1024
    ds_write_b128 v27, v[40:43] offset:2048
    ds_write_b128 v27, v[44:47] offset:3072
    ds_write_b128 v27, v[48:51] offset:4096
    ds_write_b128 v27, v[52:55] offset:5120
    ds_write_b128 v27, v[56:59] offset:6144
    ds_write_b128 v27, v[60:63] offset:7168
    s_waitcnt lgkmcnt(0)
concat_heads__gqa_block_cached__mha_block_cached__near_ridge_kernel_q0_skip:
    s_add_u32 s78, s78, 1
    s_waitcnt lgkmcnt(0)
    v_mov_b32 v5, 1
    s_mov_b64 exec, 1
    ds_add_u32 v29, v5
    s_mov_b64 exec, -1
gb13:
    ds_read_b32 v5, v29
    s_waitcnt lgkmcnt(0)
    v_readfirstlane_b32 s31, v5
    s_lshl_b32 s30, s78, 2
    s_nop 1
    s_cmp_ge_u32 s31, s30
    s_cbranch_scc1 gb13_ok
    s_sleep 0
    s_branch gb13
gb13_ok:
    v_add_u32 v27, 65536, v30
    ds_read_b128 v[64:67], v27 offset:0
    ds_read_b128 v[68:71], v27 offset:1024
    ds_read_b128 v[72:75], v27 offset:2048
    ds_read_b128 v[76:79], v27 offset:3072
    ds_read_b128 v[80:83], v27 offset:4096
    ds_read_b128 v[84:87], v27 offset:5120
    ds_read_b128 v[88:91], v27 offset:6144
    ds_read_b128 v[92:95], v27 offset:7168
    s_waitcnt lgkmcnt(0)
    s_mov_b32 s39, 0
concat_heads__gqa_block_cached__mha_block_cached__near_ridge_kernel_task:
    s_add_u32 s45, s38, s43
    s_cmp_lt_u32 s39, 3
    s_cselect_b32 s45, s45, 0x80000000
    s_waitcnt vmcnt(0)
    s_mov_b32 m0, s42
    s_add_u32 s28, s38, 32768
    buffer_load_dwordx4 v6, s[16:19], s28 offen offset:0 nt lds
    buffer_load_dwordx4 v7, s[16:19], s28 offen offset:1024 nt lds
    buffer_load_dwordx4 v8, s[16:19], s28 offen offset:2048 nt lds
    buffer_load_dwordx4 v9, s[16:19], s28 offen offset:3072 nt lds
    s_add_u32 m0, s42, 4096
    s_add_u32 s28, s28, 4096
    buffer_load_dwordx4 v6, s[16:19], s28 offen offset:0 nt lds
    buffer_load_dwordx4 v7, s[16:19], s28 offen offset:1024 nt lds
    buffer_load_dwordx4 v8, s[16:19], s28 offen offset:2048 nt lds
    buffer_load_dwordx4 v9, s[16:19], s28 offen offset:3072 nt lds
    ds_read_b128 v[160:163], v11 offset:0
    ds_read_b128 v[164:167], v12 offset:0
    ds_read_b128 v[168:171], v13 offset:0
    ds_read_b128 v[172:175], v14 offset:0
    ds_read_b128 v[176:179], v15 offset:0
    ds_read_b128 v[180:183], v16 offset:0
    ds_read_b128 v[184:187], v17 offset:0
    ds_read_b128 v[188:191], v18 offset:0
    s_waitcnt lgkmcnt(0)
    v_mfma_f32_32x32x16_bf16 v[96:111], v[160:163], v[64:67], 0
    v_mfma_f32_32x32x16_bf16 v[96:111], v[164:167], v[68:71], v[96:111]
    v_mfma_f32_32x32x16_bf16 v[96:111], v[168:171], v[72:75], v[96:111]
    v_mfma_f32_32x32x16_bf16 v[96:111], v[172:175], v[76:79], v[96:111]
    v_mfma_f32_32x32x16_bf16 v[96:111], v[176:179], v[80:83], v[96:111]
    v_mfma_f32_32x32x16_bf16 v[96:111], v[180:183], v[84:87], v[96:111]
    v_mfma_f32_32x32x16_bf16 v[96:111], v[184:187], v[88:91], v[96:111]
    v_mfma_f32_32x32x16_bf16 v[96:111], v[188:191], v[92:95], v[96:111]
    s_waitcnt vmcnt(0)
    s_mov_b32 m0, s41
    s_add_u32 s28, s38, 65536
    buffer_load_dwordx4 v6, s[16:19], s28 offen offset:0 nt lds
    buffer_load_dwordx4 v7, s[16:19], s28 offen offset:1024 nt lds
    buffer_load_dwordx4 v8, s[16:19], s28 offen offset:2048 nt lds
    buffer_load_dwordx4 v9, s[16:19], s28 offen offset:3072 nt lds
    s_add_u32 m0, s41, 4096
    s_add_u32 s28, s28, 4096
    buffer_load_dwordx4 v6, s[16:19], s28 offen offset:0 nt lds
    buffer_load_dwordx4 v7, s[16:19], s28 offen offset:1024 nt lds
    buffer_load_dwordx4 v8, s[16:19], s28 offen offset:2048 nt lds
    buffer_load_dwordx4 v9, s[16:19], s28 offen offset:3072 nt lds
    ds_read_b128 v[192:195], v11 offset:32768
    ds_read_b128 v[196:199], v12 offset:32768
    ds_read_b128 v[200:203], v13 offset:32768
    ds_read_b128 v[204:207], v14 offset:32768
    ds_read_b128 v[208:211], v15 offset:32768
    ds_read_b128 v[212:215], v16 offset:32768
    ds_read_b128 v[216:219], v17 offset:32768
    ds_read_b128 v[220:223], v18 offset:32768
    s_waitcnt lgkmcnt(0)
    v_mfma_f32_32x32x16_bf16 v[112:127], v[192:195], v[64:67], 0
    v_mfma_f32_32x32x16_bf16 v[112:127], v[196:199], v[68:71], v[112:127]
    v_mfma_f32_32x32x16_bf16 v[112:127], v[200:203], v[72:75], v[112:127]
    v_mfma_f32_32x32x16_bf16 v[112:127], v[204:207], v[76:79], v[112:127]
    v_mfma_f32_32x32x16_bf16 v[112:127], v[208:211], v[80:83], v[112:127]
    v_mfma_f32_32x32x16_bf16 v[112:127], v[212:215], v[84:87], v[112:127]
    v_mfma_f32_32x32x16_bf16 v[112:127], v[216:219], v[88:91], v[112:127]
    v_mfma_f32_32x32x16_bf16 v[112:127], v[220:223], v[92:95], v[112:127]
    s_waitcnt vmcnt(0)
    s_mov_b32 m0, s42
    s_add_u32 s28, s38, 98304
    buffer_load_dwordx4 v6, s[16:19], s28 offen offset:0 nt lds
    buffer_load_dwordx4 v7, s[16:19], s28 offen offset:1024 nt lds
    buffer_load_dwordx4 v8, s[16:19], s28 offen offset:2048 nt lds
    buffer_load_dwordx4 v9, s[16:19], s28 offen offset:3072 nt lds
    s_add_u32 m0, s42, 4096
    s_add_u32 s28, s28, 4096
    buffer_load_dwordx4 v6, s[16:19], s28 offen offset:0 nt lds
    buffer_load_dwordx4 v7, s[16:19], s28 offen offset:1024 nt lds
    buffer_load_dwordx4 v8, s[16:19], s28 offen offset:2048 nt lds
    buffer_load_dwordx4 v9, s[16:19], s28 offen offset:3072 nt lds
    ds_read_b128 v[160:163], v11 offset:0
    ds_read_b128 v[164:167], v12 offset:0
    ds_read_b128 v[168:171], v13 offset:0
    ds_read_b128 v[172:175], v14 offset:0
    ds_read_b128 v[176:179], v15 offset:0
    ds_read_b128 v[180:183], v16 offset:0
    ds_read_b128 v[184:187], v17 offset:0
    ds_read_b128 v[188:191], v18 offset:0
    s_waitcnt lgkmcnt(0)
    v_mfma_f32_32x32x16_bf16 v[128:143], v[160:163], v[64:67], 0
    v_mfma_f32_32x32x16_bf16 v[128:143], v[164:167], v[68:71], v[128:143]
    v_mfma_f32_32x32x16_bf16 v[128:143], v[168:171], v[72:75], v[128:143]
    v_mfma_f32_32x32x16_bf16 v[128:143], v[172:175], v[76:79], v[128:143]
    v_mfma_f32_32x32x16_bf16 v[128:143], v[176:179], v[80:83], v[128:143]
    v_mfma_f32_32x32x16_bf16 v[128:143], v[180:183], v[84:87], v[128:143]
    v_mfma_f32_32x32x16_bf16 v[128:143], v[184:187], v[88:91], v[128:143]
    v_mfma_f32_32x32x16_bf16 v[128:143], v[188:191], v[92:95], v[128:143]
    s_waitcnt vmcnt(0)
    s_mov_b32 m0, s41
    s_mov_b32 s28, s38
    buffer_load_dwordx4 v10, s[20:23], s28 offen offset:0 nt lds
    buffer_load_dwordx4 v10, s[20:23], s28 offen offset:1024 nt lds
    buffer_load_dwordx4 v10, s[20:23], s28 offen offset:2048 nt lds
    buffer_load_dwordx4 v10, s[20:23], s28 offen offset:3072 nt lds
    s_add_u32 m0, s41, 4096
    s_add_u32 s28, s28, 4096
    buffer_load_dwordx4 v10, s[20:23], s28 offen offset:0 nt lds
    buffer_load_dwordx4 v10, s[20:23], s28 offen offset:1024 nt lds
    buffer_load_dwordx4 v10, s[20:23], s28 offen offset:2048 nt lds
    buffer_load_dwordx4 v10, s[20:23], s28 offen offset:3072 nt lds
    ds_read_b128 v[192:195], v11 offset:32768
    ds_read_b128 v[196:199], v12 offset:32768
    ds_read_b128 v[200:203], v13 offset:32768
    ds_read_b128 v[204:207], v14 offset:32768
    ds_read_b128 v[208:211], v15 offset:32768
    ds_read_b128 v[212:215], v16 offset:32768
    ds_read_b128 v[216:219], v17 offset:32768
    ds_read_b128 v[220:223], v18 offset:32768
    s_waitcnt lgkmcnt(0)
    v_mfma_f32_32x32x16_bf16 v[144:159], v[192:195], v[64:67], 0
    v_mfma_f32_32x32x16_bf16 v[144:159], v[196:199], v[68:71], v[144:159]
    v_mfma_f32_32x32x16_bf16 v[144:159], v[200:203], v[72:75], v[144:159]
    v_mfma_f32_32x32x16_bf16 v[144:159], v[204:207], v[76:79], v[144:159]
    v_mfma_f32_32x32x16_bf16 v[144:159], v[208:211], v[80:83], v[144:159]
    v_mfma_f32_32x32x16_bf16 v[144:159], v[212:215], v[84:87], v[144:159]
    v_mfma_f32_32x32x16_bf16 v[144:159], v[216:219], v[88:91], v[144:159]
    v_mfma_f32_32x32x16_bf16 v[144:159], v[220:223], v[92:95], v[144:159]
    v_max3_f32 v25, v96, v97, v98
    v_max3_f32 v2, v99, v100, v101
    v_max3_f32 v25, v25, v102, v103
    v_max3_f32 v2, v2, v104, v105
    v_max3_f32 v25, v25, v106, v107
    v_max3_f32 v2, v2, v108, v109
    v_max3_f32 v25, v25, v110, v111
    v_max3_f32 v2, v2, v112, v113
    v_max3_f32 v25, v25, v114, v115
    v_max3_f32 v2, v2, v116, v117
    v_max3_f32 v25, v25, v118, v119
    v_max3_f32 v2, v2, v120, v121
    v_max3_f32 v25, v25, v122, v123
    v_max3_f32 v2, v2, v124, v125
    v_max3_f32 v25, v25, v126, v127
    v_max3_f32 v2, v2, v128, v129
    v_max3_f32 v25, v25, v130, v131
    v_max3_f32 v2, v2, v132, v133
    v_max3_f32 v25, v25, v134, v135
    v_max3_f32 v2, v2, v136, v137
    v_max3_f32 v25, v25, v138, v139
    v_max3_f32 v2, v2, v140, v141
    v_max3_f32 v25, v25, v142, v143
    v_max3_f32 v2, v2, v144, v145
    v_max3_f32 v25, v25, v146, v147
    v_max3_f32 v2, v2, v148, v149
    v_max3_f32 v25, v25, v150, v151
    v_max3_f32 v2, v2, v152, v153
    v_max3_f32 v25, v25, v154, v155
    v_max3_f32 v2, v2, v156, v157
    v_max3_f32 v25, v25, v158, v159
    v_max_f32 v25, v25, v2
    v_mov_b32 v2, v25
    s_nop 1
    v_permlane32_swap_b32 v25, v2
    s_nop 0
    v_max_f32 v23, v25, v2
    v_mul_f32 v26, s40, v23
    v_fma_f32 v96, v96, s40, -v26
    v_fma_f32 v97, v97, s40, -v26
    v_fma_f32 v98, v98, s40, -v26
    v_fma_f32 v99, v99, s40, -v26
    v_fma_f32 v100, v100, s40, -v26
    v_fma_f32 v101, v101, s40, -v26
    v_fma_f32 v102, v102, s40, -v26
    v_fma_f32 v103, v103, s40, -v26
    v_fma_f32 v104, v104, s40, -v26
    v_fma_f32 v105, v105, s40, -v26
    v_fma_f32 v106, v106, s40, -v26
    v_fma_f32 v107, v107, s40, -v26
    v_fma_f32 v108, v108, s40, -v26
    v_fma_f32 v109, v109, s40, -v26
    v_fma_f32 v110, v110, s40, -v26
    v_fma_f32 v111, v111, s40, -v26
    v_fma_f32 v112, v112, s40, -v26
    v_fma_f32 v113, v113, s40, -v26
    v_fma_f32 v114, v114, s40, -v26
    v_fma_f32 v115, v115, s40, -v26
    v_fma_f32 v116, v116, s40, -v26
    v_fma_f32 v117, v117, s40, -v26
    v_fma_f32 v118, v118, s40, -v26
    v_fma_f32 v119, v119, s40, -v26
    v_fma_f32 v120, v120, s40, -v26
    v_fma_f32 v121, v121, s40, -v26
    v_fma_f32 v122, v122, s40, -v26
    v_fma_f32 v123, v123, s40, -v26
    v_fma_f32 v124, v124, s40, -v26
    v_fma_f32 v125, v125, s40, -v26
    v_fma_f32 v126, v126, s40, -v26
    v_fma_f32 v127, v127, s40, -v26
    v_fma_f32 v128, v128, s40, -v26
    v_fma_f32 v129, v129, s40, -v26
    v_fma_f32 v130, v130, s40, -v26
    v_fma_f32 v131, v131, s40, -v26
    v_fma_f32 v132, v132, s40, -v26
    v_fma_f32 v133, v133, s40, -v26
    v_fma_f32 v134, v134, s40, -v26
    v_fma_f32 v135, v135, s40, -v26
    v_fma_f32 v136, v136, s40, -v26
    v_fma_f32 v137, v137, s40, -v26
    v_fma_f32 v138, v138, s40, -v26
    v_fma_f32 v139, v139, s40, -v26
    v_fma_f32 v140, v140, s40, -v26
    v_fma_f32 v141, v141, s40, -v26
    v_fma_f32 v142, v142, s40, -v26
    v_fma_f32 v143, v143, s40, -v26
    v_fma_f32 v144, v144, s40, -v26
    v_fma_f32 v145, v145, s40, -v26
    v_fma_f32 v146, v146, s40, -v26
    v_fma_f32 v147, v147, s40, -v26
    v_fma_f32 v148, v148, s40, -v26
    v_fma_f32 v149, v149, s40, -v26
    v_fma_f32 v150, v150, s40, -v26
    v_fma_f32 v151, v151, s40, -v26
    v_fma_f32 v152, v152, s40, -v26
    v_fma_f32 v153, v153, s40, -v26
    v_fma_f32 v154, v154, s40, -v26
    v_fma_f32 v155, v155, s40, -v26
    v_fma_f32 v156, v156, s40, -v26
    v_fma_f32 v157, v157, s40, -v26
    v_fma_f32 v158, v158, s40, -v26
    v_fma_f32 v159, v159, s40, -v26
    v_exp_f32 v96, v96
    v_exp_f32 v97, v97
    v_exp_f32 v98, v98
    v_exp_f32 v99, v99
    v_exp_f32 v100, v100
    v_exp_f32 v101, v101
    v_exp_f32 v102, v102
    v_exp_f32 v103, v103
    v_exp_f32 v104, v104
    v_exp_f32 v105, v105
    v_exp_f32 v106, v106
    v_exp_f32 v107, v107
    v_exp_f32 v108, v108
    v_exp_f32 v109, v109
    v_exp_f32 v110, v110
    v_exp_f32 v111, v111
    v_exp_f32 v112, v112
    v_exp_f32 v113, v113
    v_exp_f32 v114, v114
    v_exp_f32 v115, v115
    v_exp_f32 v116, v116
    v_exp_f32 v117, v117
    v_exp_f32 v118, v118
    v_exp_f32 v119, v119
    v_exp_f32 v120, v120
    v_exp_f32 v121, v121
    v_exp_f32 v122, v122
    v_exp_f32 v123, v123
    v_exp_f32 v124, v124
    v_exp_f32 v125, v125
    v_exp_f32 v126, v126
    v_exp_f32 v127, v127
    v_exp_f32 v128, v128
    v_exp_f32 v129, v129
    v_exp_f32 v130, v130
    v_exp_f32 v131, v131
    v_exp_f32 v132, v132
    v_exp_f32 v133, v133
    v_exp_f32 v134, v134
    v_exp_f32 v135, v135
    v_exp_f32 v136, v136
    v_exp_f32 v137, v137
    v_exp_f32 v138, v138
    v_exp_f32 v139, v139
    v_exp_f32 v140, v140
    v_exp_f32 v141, v141
    v_exp_f32 v142, v142
    v_exp_f32 v143, v143
    v_exp_f32 v144, v144
    v_exp_f32 v145, v145
    v_exp_f32 v146, v146
    v_exp_f32 v147, v147
    v_exp_f32 v148, v148
    v_exp_f32 v149, v149
    v_exp_f32 v150, v150
    v_exp_f32 v151, v151
    v_exp_f32 v152, v152
    v_exp_f32 v153, v153
    v_exp_f32 v154, v154
    v_exp_f32 v155, v155
    v_exp_f32 v156, v156
    v_exp_f32 v157, v157
    v_exp_f32 v158, v158
    v_exp_f32 v159, v159
    v_add_f32 v24, v96, v97
    v_add_f32 v2, v98, v99
    v_add_f32 v24, v24, v100
    v_add_f32 v2, v2, v101
    v_add_f32 v24, v24, v102
    v_add_f32 v2, v2, v103
    v_add_f32 v24, v24, v104
    v_add_f32 v2, v2, v105
    v_add_f32 v24, v24, v106
    v_add_f32 v2, v2, v107
    v_add_f32 v24, v24, v108
    v_add_f32 v2, v2, v109
    v_add_f32 v24, v24, v110
    v_add_f32 v2, v2, v111
    v_add_f32 v24, v24, v112
    v_add_f32 v2, v2, v113
    v_add_f32 v24, v24, v114
    v_add_f32 v2, v2, v115
    v_add_f32 v24, v24, v116
    v_add_f32 v2, v2, v117
    v_add_f32 v24, v24, v118
    v_add_f32 v2, v2, v119
    v_add_f32 v24, v24, v120
    v_add_f32 v2, v2, v121
    v_add_f32 v24, v24, v122
    v_add_f32 v2, v2, v123
    v_add_f32 v24, v24, v124
    v_add_f32 v2, v2, v125
    v_add_f32 v24, v24, v126
    v_add_f32 v2, v2, v127
    v_add_f32 v24, v24, v128
    v_add_f32 v2, v2, v129
    v_add_f32 v24, v24, v130
    v_add_f32 v2, v2, v131
    v_add_f32 v24, v24, v132
    v_add_f32 v2, v2, v133
    v_add_f32 v24, v24, v134
    v_add_f32 v2, v2, v135
    v_add_f32 v24, v24, v136
    v_add_f32 v2, v2, v137
    v_add_f32 v24, v24, v138
    v_add_f32 v2, v2, v139
    v_add_f32 v24, v24, v140
    v_add_f32 v2, v2, v141
    v_add_f32 v24, v24, v142
    v_add_f32 v2, v2, v143
    v_add_f32 v24, v24, v144
    v_add_f32 v2, v2, v145
    v_add_f32 v24, v24, v146
    v_add_f32 v2, v2, v147
    v_add_f32 v24, v24, v148
    v_add_f32 v2, v2, v149
    v_add_f32 v24, v24, v150
    v_add_f32 v2, v2, v151
    v_add_f32 v24, v24, v152
    v_add_f32 v2, v2, v153
    v_add_f32 v24, v24, v154
    v_add_f32 v2, v2, v155
    v_add_f32 v24, v24, v156
    v_add_f32 v2, v2, v157
    v_add_f32 v24, v24, v158
    v_add_f32 v2, v2, v159
    v_cvt_pk_bf16_f32 v96, v96, v97
    v_cvt_pk_bf16_f32 v97, v98, v99
    v_cvt_pk_bf16_f32 v98, v100, v101
    v_cvt_pk_bf16_f32 v99, v102, v103
    v_cvt_pk_bf16_f32 v100, v104, v105
    v_cvt_pk_bf16_f32 v101, v106, v107
    v_cvt_pk_bf16_f32 v102, v108, v109
    v_cvt_pk_bf16_f32 v103, v110, v111
    v_cvt_pk_bf16_f32 v104, v112, v113
    v_cvt_pk_bf16_f32 v105, v114, v115
    v_cvt_pk_bf16_f32 v106, v116, v117
    v_cvt_pk_bf16_f32 v107, v118, v119
    v_cvt_pk_bf16_f32 v108, v120, v121
    v_cvt_pk_bf16_f32 v109, v122, v123
    v_cvt_pk_bf16_f32 v110, v124, v125
    v_cvt_pk_bf16_f32 v111, v126, v127
    v_cvt_pk_bf16_f32 v112, v128, v129
    v_cvt_pk_bf16_f32 v113, v130, v131
    v_cvt_pk_bf16_f32 v114, v132, v133
    v_cvt_pk_bf16_f32 v115, v134, v135
    v_cvt_pk_bf16_f32 v116, v136, v137
    v_cvt_pk_bf16_f32 v117, v138, v139
    v_cvt_pk_bf16_f32 v118, v140, v141
    v_cvt_pk_bf16_f32 v119, v142, v143
    v_cvt_pk_bf16_f32 v120, v144, v145
    v_cvt_pk_bf16_f32 v121, v146, v147
    v_cvt_pk_bf16_f32 v122, v148, v149
    v_cvt_pk_bf16_f32 v123, v150, v151
    v_cvt_pk_bf16_f32 v124, v152, v153
    v_cvt_pk_bf16_f32 v125, v154, v155
    v_cvt_pk_bf16_f32 v126, v156, v157
    v_cvt_pk_bf16_f32 v127, v158, v159
    v_add_f32 v24, v24, v2
    v_mov_b32 v2, v24
    s_nop 1
    v_permlane32_swap_b32 v24, v2
    s_nop 0
    v_add_f32 v24, v24, v2
    s_cmp_ge_u32 s39, 3
    s_cbranch_scc1 concat_heads__gqa_block_cached__mha_block_cached__near_ridge_kernel_noq
    s_add_u32 s44, s39, 1
    s_cmp_lg_u32 s4, s44
    s_cbranch_scc1 concat_heads__gqa_block_cached__mha_block_cached__near_ridge_kernel_qn_skip
    v_add_u32 v27, 65536, v30
    ds_write_b128 v27, v[32:35] offset:0
    ds_write_b128 v27, v[36:39] offset:1024
    ds_write_b128 v27, v[40:43] offset:2048
    ds_write_b128 v27, v[44:47] offset:3072
    ds_write_b128 v27, v[48:51] offset:4096
    ds_write_b128 v27, v[52:55] offset:5120
    ds_write_b128 v27, v[56:59] offset:6144
    ds_write_b128 v27, v[60:63] offset:7168
    s_waitcnt lgkmcnt(0)
concat_heads__gqa_block_cached__mha_block_cached__near_ridge_kernel_qn_skip:
    s_add_u32 s78, s78, 1
    s_waitcnt lgkmcnt(0)
    v_mov_b32 v5, 1
    s_mov_b64 exec, 1
    ds_add_u32 v29, v5
    s_mov_b64 exec, -1
gb14:
    ds_read_b32 v5, v29
    s_waitcnt lgkmcnt(0)
    v_readfirstlane_b32 s31, v5
    s_lshl_b32 s30, s78, 2
    s_nop 1
    s_cmp_ge_u32 s31, s30
    s_cbranch_scc1 gb14_ok
    s_sleep 0
    s_branch gb14
gb14_ok:
    v_add_u32 v27, 65536, v30
    ds_read_b128 v[64:67], v27 offset:0
    ds_read_b128 v[68:71], v27 offset:1024
    ds_read_b128 v[72:75], v27 offset:2048
    ds_read_b128 v[76:79], v27 offset:3072
    ds_read_b128 v[80:83], v27 offset:4096
    ds_read_b128 v[84:87], v27 offset:5120
    ds_read_b128 v[88:91], v27 offset:6144
    ds_read_b128 v[92:95], v27 offset:7168
    s_waitcnt lgkmcnt(0)
concat_heads__gqa_block_cached__mha_block_cached__near_ridge_kernel_noq:
    s_waitcnt vmcnt(0)
    s_mov_b32 m0, s42
    s_add_u32 s28, s38, 32768
    buffer_load_dwordx4 v10, s[20:23], s28 offen offset:0 nt lds
    buffer_load_dwordx4 v10, s[20:23], s28 offen offset:1024 nt lds
    buffer_load_dwordx4 v10, s[20:23], s28 offen offset:2048 nt lds
    buffer_load_dwordx4 v10, s[20:23], s28 offen offset:3072 nt lds
    s_add_u32 m0, s42, 4096
    s_add_u32 s28, s28, 4096
    buffer_load_dwordx4 v10, s[20:23], s28 offen offset:0 nt lds
    buffer_load_dwordx4 v10, s[20:23], s28 offen offset:1024 nt lds
    buffer_load_dwordx4 v10, s[20:23], s28 offen offset:2048 nt lds
    buffer_load_dwordx4 v10, s[20:23], s28 offen offset:3072 nt lds
    ds_read_b64_tr_b16 v[128:129], v19 offset:0
    ds_read_b64_tr_b16 v[130:131], v19 offset:2048
    ds_read_b64_tr_b16 v[132:133], v19 offset:4096
    ds_read_b64_tr_b16 v[134:135], v19 offset:6144
    ds_read_b64_tr_b16 v[136:137], v20 offset:0
    ds_read_b64_tr_b16 v[138:139], v20 offset:2048
    ds_read_b64_tr_b16 v[140:141], v20 offset:4096
    ds_read_b64_tr_b16 v[142:143], v20 offset:6144
    ds_read_b64_tr_b16 v[144:145], v21 offset:0
    ds_read_b64_tr_b16 v[146:147], v21 offset:2048
    ds_read_b64_tr_b16 v[148:149], v21 offset:4096
    ds_read_b64_tr_b16 v[150:151], v21 offset:6144
    ds_read_b64_tr_b16 v[152:153], v22 offset:0
    ds_read_b64_tr_b16 v[154:155], v22 offset:2048
    ds_read_b64_tr_b16 v[156:157], v22 offset:4096
    ds_read_b64_tr_b16 v[158:159], v22 offset:6144
    s_waitcnt lgkmcnt(0)
    v_mfma_f32_32x32x16_bf16 v[160:175], v[128:131], v[96:99], 0
    v_mfma_f32_32x32x16_bf16 v[176:191], v[136:139], v[96:99], 0
    v_mfma_f32_32x32x16_bf16 v[192:207], v[144:147], v[96:99], 0
    v_mfma_f32_32x32x16_bf16 v[208:223], v[152:155], v[96:99], 0
    v_mfma_f32_32x32x16_bf16 v[160:175], v[132:135], v[100:103], v[160:175]
    v_mfma_f32_32x32x16_bf16 v[176:191], v[140:143], v[100:103], v[176:191]
    v_mfma_f32_32x32x16_bf16 v[192:207], v[148:151], v[100:103], v[192:207]
    v_mfma_f32_32x32x16_bf16 v[208:223], v[156:159], v[100:103], v[208:223]
    s_waitcnt vmcnt(0)
    s_mov_b32 m0, s41
    s_add_u32 s28, s38, 65536
    buffer_load_dwordx4 v10, s[20:23], s28 offen offset:0 nt lds
    buffer_load_dwordx4 v10, s[20:23], s28 offen offset:1024 nt lds
    buffer_load_dwordx4 v10, s[20:23], s28 offen offset:2048 nt lds
    buffer_load_dwordx4 v10, s[20:23], s28 offen offset:3072 nt lds
    s_add_u32 m0, s41, 4096
    s_add_u32 s28, s28, 4096
    buffer_load_dwordx4 v10, s[20:23], s28 offen offset:0 nt lds
    buffer_load_dwordx4 v10, s[20:23], s28 offen offset:1024 nt lds
    buffer_load_dwordx4 v10, s[20:23], s28 offen offset:2048 nt lds
    buffer_load_dwordx4 v10, s[20:23], s28 offen offset:3072 nt lds
    ds_read_b64_tr_b16 v[128:129], v19 offset:32768
    ds_read_b64_tr_b16 v[130:131], v19 offset:34816
    ds_read_b64_tr_b16 v[132:133], v19 offset:36864
    ds_read_b64_tr_b16 v[134:135], v19 offset:38912
    ds_read_b64_tr_b16 v[136:137], v20 offset:32768
    ds_read_b64_tr_b16 v[138:139], v20 offset:34816
    ds_read_b64_tr_b16 v[140:141], v20 offset:36864
    ds_read_b64_tr_b16 v[142:143], v20 offset:38912
    ds_read_b64_tr_b16 v[144:145], v21 offset:32768
    ds_read_b64_tr_b16 v[146:147], v21 offset:34816
    ds_read_b64_tr_b16 v[148:149], v21 offset:36864
    ds_read_b64_tr_b16 v[150:151], v21 offset:38912
    ds_read_b64_tr_b16 v[152:153], v22 offset:32768
    ds_read_b64_tr_b16 v[154:155], v22 offset:34816
    ds_read_b64_tr_b16 v[156:157], v22 offset:36864
    ds_read_b64_tr_b16 v[158:159], v22 offset:38912
    s_waitcnt lgkmcnt(0)
    v_mfma_f32_32x32x16_bf16 v[160:175], v[128:131], v[104:107], v[160:175]
    v_mfma_f32_32x32x16_bf16 v[176:191], v[136:139], v[104:107], v[176:191]
    v_mfma_f32_32x32x16_bf16 v[192:207], v[144:147], v[104:107], v[192:207]
    v_mfma_f32_32x32x16_bf16 v[208:223], v[152:155], v[104:107], v[208:223]
    v_mfma_f32_32x32x16_bf16 v[160:175], v[132:135], v[108:111], v[160:175]
    v_mfma_f32_32x32x16_bf16 v[176:191], v[140:143], v[108:111], v[176:191]
    v_mfma_f32_32x32x16_bf16 v[192:207], v[148:151], v[108:111], v[192:207]
    v_mfma_f32_32x32x16_bf16 v[208:223], v[156:159], v[108:111], v[208:223]
    s_waitcnt vmcnt(0)
    s_mov_b32 m0, s42
    s_add_u32 s28, s38, 98304
    buffer_load_dwordx4 v10, s[20:23], s28 offen offset:0 nt lds
    buffer_load_dwordx4 v10, s[20:23], s28 offen offset:1024 nt lds
    buffer_load_dwordx4 v10, s[20:23], s28 offen offset:2048 nt lds
    buffer_load_dwordx4 v10, s[20:23], s28 offen offset:3072 nt lds
    s_add_u32 m0, s42, 4096
    s_add_u32 s28, s28, 4096
    buffer_load_dwordx4 v10, s[20:23], s28 offen offset:0 nt lds
    buffer_load_dwordx4 v10, s[20:23], s28 offen offset:1024 nt lds
    buffer_load_dwordx4 v10, s[20:23], s28 offen offset:2048 nt lds
    buffer_load_dwordx4 v10, s[20:23], s28 offen offset:3072 nt lds
    ds_read_b64_tr_b16 v[128:129], v19 offset:0
    ds_read_b64_tr_b16 v[130:131], v19 offset:2048
    ds_read_b64_tr_b16 v[132:133], v19 offset:4096
    ds_read_b64_tr_b16 v[134:135], v19 offset:6144
    ds_read_b64_tr_b16 v[136:137], v20 offset:0
    ds_read_b64_tr_b16 v[138:139], v20 offset:2048
    ds_read_b64_tr_b16 v[140:141], v20 offset:4096
    ds_read_b64_tr_b16 v[142:143], v20 offset:6144
    ds_read_b64_tr_b16 v[144:145], v21 offset:0
    ds_read_b64_tr_b16 v[146:147], v21 offset:2048
    ds_read_b64_tr_b16 v[148:149], v21 offset:4096
    ds_read_b64_tr_b16 v[150:151], v21 offset:6144
    ds_read_b64_tr_b16 v[152:153], v22 offset:0
    ds_read_b64_tr_b16 v[154:155], v22 offset:2048
    ds_read_b64_tr_b16 v[156:157], v22 offset:4096
    ds_read_b64_tr_b16 v[158:159], v22 offset:6144
    s_waitcnt lgkmcnt(0)
    v_mfma_f32_32x32x16_bf16 v[160:175], v[128:131], v[112:115], v[160:175]
    v_mfma_f32_32x32x16_bf16 v[176:191], v[136:139], v[112:115], v[176:191]
    v_mfma_f32_32x32x16_bf16 v[192:207], v[144:147], v[112:115], v[192:207]
    v_mfma_f32_32x32x16_bf16 v[208:223], v[152:155], v[112:115], v[208:223]
    v_mfma_f32_32x32x16_bf16 v[160:175], v[132:135], v[116:119], v[160:175]
    v_mfma_f32_32x32x16_bf16 v[176:191], v[140:143], v[116:119], v[176:191]
    v_mfma_f32_32x32x16_bf16 v[192:207], v[148:151], v[116:119], v[192:207]
    v_mfma_f32_32x32x16_bf16 v[208:223], v[156:159], v[116:119], v[208:223]
    s_waitcnt vmcnt(0)
    s_mov_b32 m0, s41
    s_mov_b32 s28, s45
    buffer_load_dwordx4 v6, s[16:19], s28 offen offset:0 nt lds
    buffer_load_dwordx4 v7, s[16:19], s28 offen offset:1024 nt lds
    buffer_load_dwordx4 v8, s[16:19], s28 offen offset:2048 nt lds
    buffer_load_dwordx4 v9, s[16:19], s28 offen offset:3072 nt lds
    s_add_u32 m0, s41, 4096
    s_add_u32 s28, s28, 4096
    buffer_load_dwordx4 v6, s[16:19], s28 offen offset:0 nt lds
    buffer_load_dwordx4 v7, s[16:19], s28 offen offset:1024 nt lds
    buffer_load_dwordx4 v8, s[16:19], s28 offen offset:2048 nt lds
    buffer_load_dwordx4 v9, s[16:19], s28 offen offset:3072 nt lds
    ds_read_b64_tr_b16 v[128:129], v19 offset:32768
    ds_read_b64_tr_b16 v[130:131], v19 offset:34816
    ds_read_b64_tr_b16 v[132:133], v19 offset:36864
    ds_read_b64_tr_b16 v[134:135], v19 offset:38912
    ds_read_b64_tr_b16 v[136:137], v20 offset:32768
    ds_read_b64_tr_b16 v[138:139], v20 offset:34816
    ds_read_b64_tr_b16 v[140:141], v20 offset:36864
    ds_read_b64_tr_b16 v[142:143], v20 offset:38912
    ds_read_b64_tr_b16 v[144:145], v21 offset:32768
    ds_read_b64_tr_b16 v[146:147], v21 offset:34816
    ds_read_b64_tr_b16 v[148:149], v21 offset:36864
    ds_read_b64_tr_b16 v[150:151], v21 offset:38912
    ds_read_b64_tr_b16 v[152:153], v22 offset:32768
    ds_read_b64_tr_b16 v[154:155], v22 offset:34816
    ds_read_b64_tr_b16 v[156:157], v22 offset:36864
    ds_read_b64_tr_b16 v[158:159], v22 offset:38912
    s_waitcnt lgkmcnt(0)
    v_mfma_f32_32x32x16_bf16 v[160:175], v[128:131], v[120:123], v[160:175]
    v_mfma_f32_32x32x16_bf16 v[176:191], v[136:139], v[120:123], v[176:191]
    v_mfma_f32_32x32x16_bf16 v[192:207], v[144:147], v[120:123], v[192:207]
    v_mfma_f32_32x32x16_bf16 v[208:223], v[152:155], v[120:123], v[208:223]
    v_mfma_f32_32x32x16_bf16 v[160:175], v[132:135], v[124:127], v[160:175]
    v_mfma_f32_32x32x16_bf16 v[176:191], v[140:143], v[124:127], v[176:191]
    v_mfma_f32_32x32x16_bf16 v[192:207], v[148:151], v[124:127], v[192:207]
    v_mfma_f32_32x32x16_bf16 v[208:223], v[156:159], v[124:127], v[208:223]
    v_and_b32 v2, 31, v0
    v_lshlrev_b32 v2, 3, v2
    v_add_u32 v2, 73728, v2
    v_add_u32 v2, s100, v2
    s_lshl_b32 s28, s4, 8
    v_add_u32 v27, s28, v2
    v_add_u32 v28, s42, v1
    ds_write_b32 v27, v23
    ds_write_b32 v27, v24 offset:4
    s_nop 9
    ds_write_b128 v28, v[176:179] offset:0
    ds_write_b128 v28, v[180:183] offset:1024
    ds_write_b128 v28, v[184:187] offset:2048
    ds_write_b128 v28, v[188:191] offset:3072
    ds_write_b128 v28, v[192:195] offset:4096
    ds_write_b128 v28, v[196:199] offset:5120
    ds_write_b128 v28, v[200:203] offset:6144
    ds_write_b128 v28, v[204:207] offset:7168
    s_waitcnt lgkmcnt(0)
    s_add_u32 s78, s78, 1
    s_waitcnt lgkmcnt(0)
    v_mov_b32 v5, 1
    s_mov_b64 exec, 1
    ds_add_u32 v29, v5
    s_mov_b64 exec, -1
gb15:
    ds_read_b32 v5, v29
    s_waitcnt lgkmcnt(0)
    v_readfirstlane_b32 s31, v5
    s_lshl_b32 s30, s78, 2
    s_nop 1
    s_cmp_ge_u32 s31, s30
    s_cbranch_scc1 gb15_ok
    s_sleep 0
    s_branch gb15
gb15_ok:
    s_sub_u32 s28, s4, 0
    s_and_b32 s28, s28, 3
    s_lshl_b32 s28, s28, 8
    v_add_u32 v27, s28, v2
    ds_read_b64 v[128:129], v27
    s_sub_u32 s28, s4, 1
    s_and_b32 s28, s28, 3
    s_lshl_b32 s28, s28, 8
    v_add_u32 v27, s28, v2
    ds_read_b64 v[130:131], v27
    s_sub_u32 s28, s4, 2
    s_and_b32 s28, s28, 3
    s_lshl_b32 s28, s28, 8
    v_add_u32 v27, s28, v2
    ds_read_b64 v[132:133], v27
    s_sub_u32 s28, s4, 3
    s_and_b32 s28, s28, 3
    s_lshl_b32 s28, s28, 8
    v_add_u32 v27, s28, v2
    ds_read_b64 v[134:135], v27
    s_sub_u32 s28, s4, 1
    s_and_b32 s28, s28, 3
    s_lshl_b32 s28, s28, 13
    s_add_u32 s28, s28, 32768
    v_add_u32 v27, s28, v30
    ds_read_b128 v[96:99], v27 offset:0
    ds_read_b128 v[100:103], v27 offset:1024
    ds_read_b128 v[104:107], v27 offset:2048
    ds_read_b128 v[108:111], v27 offset:3072
    s_sub_u32 s28, s4, 2
    s_and_b32 s28, s28, 3
    s_lshl_b32 s28, s28, 13
    s_add_u32 s28, s28, 36864
    v_add_u32 v27, s28, v30
    ds_read_b128 v[112:115], v27 offset:0
    ds_read_b128 v[116:119], v27 offset:1024
    ds_read_b128 v[120:123], v27 offset:2048
    ds_read_b128 v[124:127], v27 offset:3072
    s_waitcnt lgkmcnt(8)
    v_max3_f32 v25, v128, v130, v132
    v_max_f32 v25, v25, v134
    v_mul_f32 v25, s40, v25
    v_fma_f32 v128, v128, s40, -v25
    v_fma_f32 v130, v130, s40, -v25
    v_fma_f32 v132, v132, s40, -v25
    v_fma_f32 v134, v134, s40, -v25
    v_exp_f32 v128, v128
    v_exp_f32 v130, v130
    v_exp_f32 v132, v132
    v_exp_f32 v134, v134
    s_nop 0
    v_mul_f32 v26, v128, v129
    v_fma_f32 v26, v130, v131, v26
    v_fma_f32 v26, v132, v133, v26
    v_fma_f32 v26, v134, v135, v26
    v_rcp_f32 v26, v26
    s_nop 0
    v_mul_f32 v128, v128, v26
    v_mul_f32 v130, v130, v26
    v_mul_f32 v132, v132, v26
    v_mul_f32 v134, v134, v26
    v_mul_f32 v160, v160, v128
    v_mul_f32 v161, v161, v128
    v_mul_f32 v162, v162, v128
    v_mul_f32 v163, v163, v128
    v_mul_f32 v164, v164, v128
    v_mul_f32 v165, v165, v128
    v_mul_f32 v166, v166, v128
    v_mul_f32 v167, v167, v128
    v_mul_f32 v168, v168, v128
    v_mul_f32 v169, v169, v128
    v_mul_f32 v170, v170, v128
    v_mul_f32 v171, v171, v128
    v_mul_f32 v172, v172, v128
    v_mul_f32 v173, v173, v128
    v_mul_f32 v174, v174, v128
    v_mul_f32 v175, v175, v128
    s_waitcnt lgkmcnt(0)
    v_fma_f32 v160, v96, v130, v160
    v_fma_f32 v161, v97, v130, v161
    v_fma_f32 v162, v98, v130, v162
    v_fma_f32 v163, v99, v130, v163
    v_fma_f32 v164, v100, v130, v164
    v_fma_f32 v165, v101, v130, v165
    v_fma_f32 v166, v102, v130, v166
    v_fma_f32 v167, v103, v130, v167
    v_fma_f32 v168, v104, v130, v168
    v_fma_f32 v169, v105, v130, v169
    v_fma_f32 v170, v106, v130, v170
    v_fma_f32 v171, v107, v130, v171
    v_fma_f32 v172, v108, v130, v172
    v_fma_f32 v173, v109, v130, v173
    v_fma_f32 v174, v110, v130, v174
    v_fma_f32 v175, v111, v130, v175
    v_fma_f32 v160, v112, v132, v160
    v_fma_f32 v161, v113, v132, v161
    v_fma_f32 v162, v114, v132, v162
    v_fma_f32 v163, v115, v132, v163
    v_fma_f32 v164, v116, v132, v164
    v_fma_f32 v165, v117, v132, v165
    v_fma_f32 v166, v118, v132, v166
    v_fma_f32 v167, v119, v132, v167
    v_fma_f32 v168, v120, v132, v168
    v_fma_f32 v169, v121, v132, v169
    v_fma_f32 v170, v122, v132, v170
    v_fma_f32 v171, v123, v132, v171
    v_fma_f32 v172, v124, v132, v172
    v_fma_f32 v173, v125, v132, v173
    v_fma_f32 v174, v126, v132, v174
    v_fma_f32 v175, v127, v132, v175
    s_add_u32 s78, s78, 1
    s_waitcnt lgkmcnt(0)
    v_mov_b32 v5, 1
    s_mov_b64 exec, 1
    ds_add_u32 v29, v5
    s_mov_b64 exec, -1
gb16:
    ds_read_b32 v5, v29
    s_waitcnt lgkmcnt(0)
    v_readfirstlane_b32 s31, v5
    s_lshl_b32 s30, s78, 2
    s_nop 1
    s_cmp_ge_u32 s31, s30
    s_cbranch_scc1 gb16_ok
    s_sleep 0
    s_branch gb16
gb16_ok:
    ds_write_b128 v28, v[208:211] offset:0
    ds_write_b128 v28, v[212:215] offset:1024
    ds_write_b128 v28, v[216:219] offset:2048
    ds_write_b128 v28, v[220:223] offset:3072
    s_waitcnt lgkmcnt(0)
    s_add_u32 s78, s78, 1
    s_waitcnt lgkmcnt(0)
    v_mov_b32 v5, 1
    s_mov_b64 exec, 1
    ds_add_u32 v29, v5
    s_mov_b64 exec, -1
gb17:
    ds_read_b32 v5, v29
    s_waitcnt lgkmcnt(0)
    v_readfirstlane_b32 s31, v5
    s_lshl_b32 s30, s78, 2
    s_nop 1
    s_cmp_ge_u32 s31, s30
    s_cbranch_scc1 gb17_ok
    s_sleep 0
    s_branch gb17
gb17_ok:
    s_sub_u32 s28, s4, 3
    s_and_b32 s28, s28, 3
    s_lshl_b32 s28, s28, 13
    s_add_u32 s28, s28, 32768
    v_add_u32 v27, s28, v30
    ds_read_b128 v[96:99], v27 offset:0
    ds_read_b128 v[100:103], v27 offset:1024
    ds_read_b128 v[104:107], v27 offset:2048
    ds_read_b128 v[108:111], v27 offset:3072
    s_waitcnt lgkmcnt(0)
    s_add_u32 s78, s78, 1
    s_waitcnt lgkmcnt(0)
    v_mov_b32 v5, 1
    s_mov_b64 exec, 1
    ds_add_u32 v29, v5
    s_mov_b64 exec, -1
gb18:
    ds_read_b32 v5, v29
    s_waitcnt lgkmcnt(0)
    v_readfirstlane_b32 s31, v5
    s_lshl_b32 s30, s78, 2
    s_nop 1
    s_cmp_ge_u32 s31, s30
    s_cbranch_scc1 gb18_ok
    s_sleep 0
    s_branch gb18
gb18_ok:
    v_fma_f32 v160, v96, v134, v160
    v_fma_f32 v161, v97, v134, v161
    v_fma_f32 v162, v98, v134, v162
    v_fma_f32 v163, v99, v134, v163
    v_fma_f32 v164, v100, v134, v164
    v_fma_f32 v165, v101, v134, v165
    v_fma_f32 v166, v102, v134, v166
    v_fma_f32 v167, v103, v134, v167
    v_fma_f32 v168, v104, v134, v168
    v_fma_f32 v169, v105, v134, v169
    v_fma_f32 v170, v106, v134, v170
    v_fma_f32 v171, v107, v134, v171
    v_fma_f32 v172, v108, v134, v172
    v_fma_f32 v173, v109, v134, v173
    v_fma_f32 v174, v110, v134, v174
    v_fma_f32 v175, v111, v134, v175
    v_mov_b32 v224, v232
    v_mov_b32 v225, v233
    v_mov_b32 v226, v234
    v_mov_b32 v227, v235
    v_mov_b32 v228, v236
    v_mov_b32 v229, v237
    v_mov_b32 v230, v238
    v_mov_b32 v231, v239
    v_mov_b32 v232, v240
    v_mov_b32 v233, v241
    v_mov_b32 v234, v242
    v_mov_b32 v235, v243
    v_mov_b32 v236, v244
    v_mov_b32 v237, v245
    v_mov_b32 v238, v246
    v_mov_b32 v239, v247
    v_mov_b32 v240, v248
    v_mov_b32 v241, v249
    v_mov_b32 v242, v250
    v_mov_b32 v243, v251
    v_mov_b32 v244, v252
    v_mov_b32 v245, v253
    v_mov_b32 v246, v254
    v_mov_b32 v247, v255
    v_cvt_pk_bf16_f32 v248, v160, v161
    v_cvt_pk_bf16_f32 v249, v162, v163
    v_cvt_pk_bf16_f32 v250, v164, v165
    v_cvt_pk_bf16_f32 v251, v166, v167
    v_cvt_pk_bf16_f32 v252, v168, v169
    v_cvt_pk_bf16_f32 v253, v170, v171
    v_cvt_pk_bf16_f32 v254, v172, v173
    v_cvt_pk_bf16_f32 v255, v174, v175
    s_mov_b32 s38, s45
    s_add_u32 s39, s39, 1
    s_cmp_lt_u32 s39, 4
    s_cbranch_scc1 concat_heads__gqa_block_cached__mha_block_cached__near_ridge_kernel_task
    s_waitcnt vmcnt(0)
    s_xor_b32 s28, s5, 1
    s_lshl_b32 s28, s28, 23
    s_lshl_b32 s29, s7, 18
    s_add_u32 s28, s28, s29
    s_lshl_b32 s29, s6, 13
    s_add_u32 s28, s28, s29
    s_lshl_b32 s29, s4, 11
    s_add_u32 s28, s28, s29
    buffer_store_dwordx4 v[224:227], v1, s[24:27], s28 offen offset:0 sc1
    buffer_store_dwordx4 v[228:231], v1, s[24:27], s28 offen offset:1024 sc1
    s_add_u32 s28, s28, 2097152
    buffer_store_dwordx4 v[232:235], v1, s[24:27], s28 offen offset:0 sc1
    buffer_store_dwordx4 v[236:239], v1, s[24:27], s28 offen offset:1024 sc1
    s_add_u32 s28, s28, 2097152
    buffer_store_dwordx4 v[240:243], v1, s[24:27], s28 offen offset:0 sc1
    buffer_store_dwordx4 v[244:247], v1, s[24:27], s28 offen offset:1024 sc1
    s_add_u32 s28, s28, 2097152
    buffer_store_dwordx4 v[248:251], v1, s[24:27], s28 offen offset:0 sc1
    buffer_store_dwordx4 v[252:255], v1, s[24:27], s28 offen offset:1024 sc1
    s_branch concat_heads__gqa_block_cached__mha_block_cached__near_ridge_kernel_end
concat_heads__gqa_block_cached__mha_block_cached__near_ridge_kernel_rolea:
    s_setprio 0
    s_lshl_b32 s28, s3, 5
    s_add_u32 s28, s28, s6
    s_lshl_b32 s28, s28, 13
    s_add_u32 s28, s28, 33554432
    buffer_store_dwordx4 v[32:35], v1, s[24:27], s28 offen offset:0 sc0 sc1
    buffer_store_dwordx4 v[36:39], v1, s[24:27], s28 offen offset:1024 sc0 sc1
    buffer_store_dwordx4 v[40:43], v1, s[24:27], s28 offen offset:2048 sc0 sc1
    buffer_store_dwordx4 v[44:47], v1, s[24:27], s28 offen offset:3072 sc0 sc1
    s_add_u32 s28, s28, 4096
    buffer_store_dwordx4 v[48:51], v1, s[24:27], s28 offen offset:0 sc0 sc1
    buffer_store_dwordx4 v[52:55], v1, s[24:27], s28 offen offset:1024 sc0 sc1
    buffer_store_dwordx4 v[56:59], v1, s[24:27], s28 offen offset:2048 sc0 sc1
    buffer_store_dwordx4 v[60:63], v1, s[24:27], s28 offen offset:3072 sc0 sc1
    s_waitcnt vmcnt(0)
    s_add_u32 s78, s78, 1
    s_waitcnt lgkmcnt(0)
    v_mov_b32 v5, 1
    s_mov_b64 exec, 1
    ds_add_u32 v29, v5
    s_mov_b64 exec, -1
gb19:
    ds_read_b32 v5, v29
    s_waitcnt lgkmcnt(0)
    v_readfirstlane_b32 s31, v5
    s_lshl_b32 s30, s78, 2
    s_nop 1
    s_cmp_ge_u32 s31, s30
    s_cbranch_scc1 gb19_ok
    s_sleep 0
    s_branch gb19
gb19_ok:
    v_readfirstlane_b32 s93, v31
    s_nop 2
    s_mul_i32 s93, s93, 0x9e3779b1
    s_add_u32 s93, s93, 0x7f4a7c15
    s_cmp_lg_u32 s4, 0
    s_cbranch_scc1 concat_heads__gqa_block_cached__mha_block_cached__near_ridge_kernel_qwait
    s_and_b32 s28, s6, 3
    s_lshl_b32 s28, s28, 2
    s_add_u32 s28, s28, s92
    s_add_u32 s28, s28, 16
    v_mov_b32 v2, 0
    v_mov_b32 v3, s93
    v_cmp_eq_u32 vcc, 0, v0
    s_and_saveexec_b64 s[30:31], vcc
    buffer_store_dword v3, v2, s[24:27], s28 offen sc0 sc1
    s_mov_b64 exec, s[30:31]
    s_add_u32 s56, s24, s92
    s_addc_u32 s57, s25, 0
concat_heads__gqa_block_cached__mha_block_cached__near_ridge_kernel_spinq:
    s_load_dwordx4 s[52:55], s[56:57], 16 glc
    s_waitcnt lgkmcnt(0)
    s_xor_b32 s28, s52, s93
    s_xor_b32 s29, s53, s93
    s_or_b32 s28, s28, s29
    s_xor_b32 s29, s54, s93
    s_or_b32 s28, s28, s29
    s_xor_b32 s29, s55, s93
    s_or_b32 s28, s28, s29
    s_cmp_eq_u32 s28, 0
    s_cbranch_scc1 concat_heads__gqa_block_cached__mha_block_cached__near_ridge_kernel_pollq
    s_sleep 2
    s_branch concat_heads__gqa_block_cached__mha_block_cached__near_ridge_kernel_spinq
concat_heads__gqa_block_cached__mha_block_cached__near_ridge_kernel_pollq:
    buffer_load_dwordx4 v[96:99], v2, s[24:27], s92 offen offset:16 sc0 sc1
    s_waitcnt vmcnt(0)
    v_xor_b32 v96, s93, v96
    v_xor_b32 v97, s93, v97
    v_xor_b32 v98, s93, v98
    v_xor_b32 v99, s93, v99
    v_or3_b32 v96, v96, v97, v98
    v_or_b32 v96, v96, v99
    s_nop 0
    v_readfirstlane_b32 s29, v96
    s_nop 2
    s_cmp_eq_u32 s29, 0
    s_cbranch_scc1 concat_heads__gqa_block_cached__mha_block_cached__near_ridge_kernel_pollq_ok
    s_sleep 32
    s_branch concat_heads__gqa_block_cached__mha_block_cached__near_ridge_kernel_pollq
concat_heads__gqa_block_cached__mha_block_cached__near_ridge_kernel_pollq_ok:
    v_cmp_eq_u32 vcc, 0, v0
    s_and_saveexec_b64 s[30:31], vcc
    buffer_store_dword v3, v2, s[24:27], s92 offen sc0 sc1
    s_mov_b64 exec, s[30:31]
    s_waitcnt vmcnt(0)
concat_heads__gqa_block_cached__mha_block_cached__near_ridge_kernel_qwait:
    s_add_u32 s78, s78, 1
    s_waitcnt lgkmcnt(0)
    v_mov_b32 v5, 1
    s_mov_b64 exec, 1
    ds_add_u32 v29, v5
    s_mov_b64 exec, -1
gb20:
    ds_read_b32 v5, v29
    s_waitcnt lgkmcnt(0)
    v_readfirstlane_b32 s31, v5
    s_lshl_b32 s30, s78, 2
    s_nop 1
    s_cmp_ge_u32 s31, s30
    s_cbranch_scc1 gb20_ok
    s_sleep 0
    s_branch gb20
gb20_ok:
    s_lshl_b32 s28, s84, 5
    s_lshl_b32 s29, s85, 2
    s_add_u32 s29, s29, s4
    s_add_u32 s28, s28, s29
    s_lshl_b32 s28, s28, 13
    s_add_u32 s28, s28, 33554432
    buffer_load_dwordx4 v[64:67], v1, s[24:27], s28 offen offset:0 sc0 sc1
    buffer_load_dwordx4 v[68:71], v1, s[24:27], s28 offen offset:1024 sc0 sc1
    buffer_load_dwordx4 v[72:75], v1, s[24:27], s28 offen offset:2048 sc0 sc1
    buffer_load_dwordx4 v[76:79], v1, s[24:27], s28 offen offset:3072 sc0 sc1
    s_add_u32 s28, s28, 4096
    buffer_load_dwordx4 v[80:83], v1, s[24:27], s28 offen offset:0 sc0 sc1
    buffer_load_dwordx4 v[84:87], v1, s[24:27], s28 offen offset:1024 sc0 sc1
    buffer_load_dwordx4 v[88:91], v1, s[24:27], s28 offen offset:2048 sc0 sc1
    buffer_load_dwordx4 v[92:95], v1, s[24:27], s28 offen offset:3072 sc0 sc1
    s_mov_b32 m0, s41
    s_mov_b32 s28, s38
    buffer_load_dwordx4 v6, s[16:19], s28 offen offset:0  lds
    buffer_load_dwordx4 v7, s[16:19], s28 offen offset:1024  lds
    buffer_load_dwordx4 v8, s[16:19], s28 offen offset:2048  lds
    buffer_load_dwordx4 v9, s[16:19], s28 offen offset:3072  lds
    s_add_u32 m0, s41, 4096
    s_add_u32 s28, s28, 4096
    buffer_load_dwordx4 v6, s[16:19], s28 offen offset:0  lds
    buffer_load_dwordx4 v7, s[16:19], s28 offen offset:1024  lds
    buffer_load_dwordx4 v8, s[16:19], s28 offen offset:2048  lds
    buffer_load_dwordx4 v9, s[16:19], s28 offen offset:3072  lds
    s_mov_b32 m0, s42
    s_mov_b32 s28, s38
    buffer_load_dwordx4 v10, s[20:23], s28 offen offset:0  lds
    buffer_load_dwordx4 v10, s[20:23], s28 offen offset:1024  lds
    buffer_load_dwordx4 v10, s[20:23], s28 offen offset:2048  lds
    buffer_load_dwordx4 v10, s[20:23], s28 offen offset:3072  lds
    s_add_u32 m0, s42, 4096
    s_add_u32 s28, s28, 4096
    buffer_load_dwordx4 v10, s[20:23], s28 offen offset:0  lds
    buffer_load_dwordx4 v10, s[20:23], s28 offen offset:1024  lds
    buffer_load_dwordx4 v10, s[20:23], s28 offen offset:2048  lds
    buffer_load_dwordx4 v10, s[20:23], s28 offen offset:3072  lds
    v_subrev_u32 v11, s101, v11
    v_subrev_u32 v12, s101, v12
    v_subrev_u32 v13, s101, v13
    v_subrev_u32 v14, s101, v14
    v_subrev_u32 v15, s101, v15
    v_subrev_u32 v16, s101, v16
    v_subrev_u32 v17, s101, v17
    v_subrev_u32 v18, s101, v18
    s_lshl_b32 s28, s4, 6
    v_subrev_u32 v4, s101, v19
    v_xor_b32 v4, s28, v4
    v_xor_b32 v19, 0, v4
    v_xor_b32 v20, 64, v4
    v_xor_b32 v21, 128, v4
    v_xor_b32 v22, 192, v4
    v_mov_b32 v160, 0
    v_mov_b32 v161, 0
    v_mov_b32 v162, 0
    v_mov_b32 v163, 0
    v_mov_b32 v164, 0
    v_mov_b32 v165, 0
    v_mov_b32 v166, 0
    v_mov_b32 v167, 0
    v_mov_b32 v168, 0
    v_mov_b32 v169, 0
    v_mov_b32 v170, 0
    v_mov_b32 v171, 0
    v_mov_b32 v172, 0
    v_mov_b32 v173, 0
    v_mov_b32 v174, 0
    v_mov_b32 v175, 0
    v_mov_b32 v176, 0
    v_mov_b32 v177, 0
    v_mov_b32 v178, 0
    v_mov_b32 v179, 0
    v_mov_b32 v180, 0
    v_mov_b32 v181, 0
    v_mov_b32 v182, 0
    v_mov_b32 v183, 0
    v_mov_b32 v184, 0
    v_mov_b32 v185, 0
    v_mov_b32 v186, 0
    v_mov_b32 v187, 0
    v_mov_b32 v188, 0
    v_mov_b32 v189, 0
    v_mov_b32 v190, 0
    v_mov_b32 v191, 0
    v_mov_b32 v192, 0
    v_mov_b32 v193, 0
    v_mov_b32 v194, 0
    v_mov_b32 v195, 0
    v_mov_b32 v196, 0
    v_mov_b32 v197, 0
    v_mov_b32 v198, 0
    v_mov_b32 v199, 0
    v_mov_b32 v200, 0
    v_mov_b32 v201, 0
    v_mov_b32 v202, 0
    v_mov_b32 v203, 0
    v_mov_b32 v204, 0
    v_mov_b32 v205, 0
    v_mov_b32 v206, 0
    v_mov_b32 v207, 0
    v_mov_b32 v208, 0
    v_mov_b32 v209, 0
    v_mov_b32 v210, 0
    v_mov_b32 v211, 0
    v_mov_b32 v212, 0
    v_mov_b32 v213, 0
    v_mov_b32 v214, 0
    v_mov_b32 v215, 0
    v_mov_b32 v216, 0
    v_mov_b32 v217, 0
    v_mov_b32 v218, 0
    v_mov_b32 v219, 0
    v_mov_b32 v220, 0
    v_mov_b32 v221, 0
    v_mov_b32 v222, 0
    v_mov_b32 v223, 0
    v_mov_b32 v23, 0xff7fffff
    v_mov_b32 v24, 0
    s_mov_b32 s39, 0
concat_heads__gqa_block_cached__mha_block_cached__near_ridge_kernel_chunk:
    s_add_u32 s44, s38, 32768
    s_cmp_lt_u32 s39, 3
    s_cselect_b32 s44, s44, 0x80000000
    s_waitcnt vmcnt(8)
    s_add_u32 s78, s78, 1
    s_waitcnt lgkmcnt(0)
    v_mov_b32 v5, 1
    s_mov_b64 exec, 1
    ds_add_u32 v29, v5
    s_mov_b64 exec, -1
gb21:
    ds_read_b32 v5, v29
    s_waitcnt lgkmcnt(0)
    v_readfirstlane_b32 s31, v5
    s_lshl_b32 s30, s78, 2
    s_nop 1
    s_cmp_ge_u32 s31, s30
    s_cbranch_scc1 gb21_ok
    s_sleep 0
    s_branch gb21
gb21_ok:
    ds_read_b128 v[32:35], v11 offset:0
    ds_read_b128 v[36:39], v12 offset:0
    ds_read_b128 v[40:43], v13 offset:0
    ds_read_b128 v[44:47], v14 offset:0
    ds_read_b128 v[48:51], v15 offset:0
    ds_read_b128 v[52:55], v16 offset:0
    ds_read_b128 v[56:59], v17 offset:0
    ds_read_b128 v[60:63], v18 offset:0
    ds_read_b128 v[224:227], v11 offset:8192
    ds_read_b128 v[228:231], v12 offset:8192
    ds_read_b128 v[232:235], v13 offset:8192
    ds_read_b128 v[236:239], v14 offset:8192
    ds_read_b128 v[240:243], v15 offset:8192
    ds_read_b128 v[244:247], v16 offset:8192
    ds_read_b128 v[248:251], v17 offset:8192
    ds_read_b128 v[252:255], v18 offset:8192
    s_waitcnt lgkmcnt(8)
    v_mfma_f32_32x32x16_bf16 v[96:111], v[32:35], v[64:67], 0
    v_mfma_f32_32x32x16_bf16 v[96:111], v[36:39], v[68:71], v[96:111]
    v_mfma_f32_32x32x16_bf16 v[96:111], v[40:43], v[72:75], v[96:111]
    v_mfma_f32_32x32x16_bf16 v[96:111], v[44:47], v[76:79], v[96:111]
    v_mfma_f32_32x32x16_bf16 v[96:111], v[48:51], v[80:83], v[96:111]
    v_mfma_f32_32x32x16_bf16 v[96:111], v[52:55], v[84:87], v[96:111]
    v_mfma_f32_32x32x16_bf16 v[96:111], v[56:59], v[88:91], v[96:111]
    v_mfma_f32_32x32x16_bf16 v[96:111], v[60:63], v[92:95], v[96:111]
    ds_read_b128 v[32:35], v11 offset:16384
    ds_read_b128 v[36:39], v12 offset:16384
    ds_read_b128 v[40:43], v13 offset:16384
    ds_read_b128 v[44:47], v14 offset:16384
    ds_read_b128 v[48:51], v15 offset:16384
    ds_read_b128 v[52:55], v16 offset:16384
    ds_read_b128 v[56:59], v17 offset:16384
    ds_read_b128 v[60:63], v18 offset:16384
    s_waitcnt lgkmcnt(8)
    v_mfma_f32_32x32x16_bf16 v[112:127], v[224:227], v[64:67], 0
    v_mfma_f32_32x32x16_bf16 v[112:127], v[228:231], v[68:71], v[112:127]
    v_mfma_f32_32x32x16_bf16 v[112:127], v[232:235], v[72:75], v[112:127]
    v_mfma_f32_32x32x16_bf16 v[112:127], v[236:239], v[76:79], v[112:127]
    v_mfma_f32_32x32x16_bf16 v[112:127], v[240:243], v[80:83], v[112:127]
    v_mfma_f32_32x32x16_bf16 v[112:127], v[244:247], v[84:87], v[112:127]
    v_mfma_f32_32x32x16_bf16 v[112:127], v[248:251], v[88:91], v[112:127]
    v_mfma_f32_32x32x16_bf16 v[112:127], v[252:255], v[92:95], v[112:127]
    ds_read_b128 v[224:227], v11 offset:24576
    ds_read_b128 v[228:231], v12 offset:24576
    ds_read_b128 v[232:235], v13 offset:24576
    ds_read_b128 v[236:239], v14 offset:24576
    ds_read_b128 v[240:243], v15 offset:24576
    ds_read_b128 v[244:247], v16 offset:24576
    ds_read_b128 v[248:251], v17 offset:24576
    ds_read_b128 v[252:255], v18 offset:24576
    s_waitcnt lgkmcnt(8)
    v_mfma_f32_32x32x16_bf16 v[128:143], v[32:35], v[64:67], 0
    v_mfma_f32_32x32x16_bf16 v[128:143], v[36:39], v[68:71], v[128:143]
    v_mfma_f32_32x32x16_bf16 v[128:143], v[40:43], v[72:75], v[128:143]
    v_mfma_f32_32x32x16_bf16 v[128:143], v[44:47], v[76:79], v[128:143]
    v_mfma_f32_32x32x16_bf16 v[128:143], v[48:51], v[80:83], v[128:143]
    v_mfma_f32_32x32x16_bf16 v[128:143], v[52:55], v[84:87], v[128:143]
    v_mfma_f32_32x32x16_bf16 v[128:143], v[56:59], v[88:91], v[128:143]
    v_mfma_f32_32x32x16_bf16 v[128:143], v[60:63], v[92:95], v[128:143]
    s_waitcnt lgkmcnt(0)
    s_add_u32 s78, s78, 1
    s_waitcnt lgkmcnt(0)
    v_mov_b32 v5, 1
    s_mov_b64 exec, 1
    ds_add_u32 v29, v5
    s_mov_b64 exec, -1
gb22:
    ds_read_b32 v5, v29
    s_waitcnt lgkmcnt(0)
    v_readfirstlane_b32 s31, v5
    s_lshl_b32 s30, s78, 2
    s_nop 1
    s_cmp_ge_u32 s31, s30
    s_cbranch_scc1 gb22_ok
    s_sleep 0
    s_branch gb22
gb22_ok:
    s_mov_b32 m0, s41
    s_mov_b32 s28, s44
    buffer_load_dwordx4 v6, s[16:19], s28 offen offset:0  lds
    buffer_load_dwordx4 v7, s[16:19], s28 offen offset:1024  lds
    buffer_load_dwordx4 v8, s[16:19], s28 offen offset:2048  lds
    buffer_load_dwordx4 v9, s[16:19], s28 offen offset:3072  lds
    s_add_u32 m0, s41, 4096
    s_add_u32 s28, s28, 4096
    buffer_load_dwordx4 v6, s[16:19], s28 offen offset:0  lds
    buffer_load_dwordx4 v7, s[16:19], s28 offen offset:1024  lds
    buffer_load_dwordx4 v8, s[16:19], s28 offen offset:2048  lds
    buffer_load_dwordx4 v9, s[16:19], s28 offen offset:3072  lds
    v_mfma_f32_32x32x16_bf16 v[144:159], v[224:227], v[64:67], 0
    v_mfma_f32_32x32x16_bf16 v[144:159], v[228:231], v[68:71], v[144:159]
    v_mfma_f32_32x32x16_bf16 v[144:159], v[232:235], v[72:75], v[144:159]
    v_mfma_f32_32x32x16_bf16 v[144:159], v[236:239], v[76:79], v[144:159]
    v_mfma_f32_32x32x16_bf16 v[144:159], v[240:243], v[80:83], v[144:159]
    v_mfma_f32_32x32x16_bf16 v[144:159], v[244:247], v[84:87], v[144:159]
    v_mfma_f32_32x32x16_bf16 v[144:159], v[248:251], v[88:91], v[144:159]
    v_mfma_f32_32x32x16_bf16 v[144:159], v[252:255], v[92:95], v[144:159]
    v_max3_f32 v25, v96, v97, v98
    v_max3_f32 v2, v99, v100, v101
    v_max3_f32 v25, v25, v102, v103
    v_max3_f32 v2, v2, v104, v105
    v_max3_f32 v25, v25, v106, v107
    v_max3_f32 v2, v2, v108, v109
    v_max3_f32 v25, v25, v110, v111
    v_max3_f32 v2, v2, v112, v113
    v_max3_f32 v25, v25, v114, v115
    v_max3_f32 v2, v2, v116, v117
    v_max3_f32 v25, v25, v118, v119
    v_max3_f32 v2, v2, v120, v121
    v_max3_f32 v25, v25, v122, v123
    v_max3_f32 v2, v2, v124, v125
    v_max3_f32 v25, v25, v126, v127
    v_max3_f32 v2, v2, v128, v129
    v_max3_f32 v25, v25, v130, v131
    v_max3_f32 v2, v2, v132, v133
    v_max3_f32 v25, v25, v134, v135
    v_max3_f32 v2, v2, v136, v137
    v_max3_f32 v25, v25, v138, v139
    v_max3_f32 v2, v2, v140, v141
    v_max3_f32 v25, v25, v142, v143
    v_max3_f32 v2, v2, v144, v145
    v_max3_f32 v25, v25, v146, v147
    v_max3_f32 v2, v2, v148, v149
    v_max3_f32 v25, v25, v150, v151
    v_max3_f32 v2, v2, v152, v153
    v_max3_f32 v25, v25, v154, v155
    v_max3_f32 v2, v2, v156, v157
    v_max3_f32 v25, v25, v158, v159
    v_max3_f32 v25, v25, v2, v23
    v_mov_b32 v2, v25
    s_nop 1
    v_permlane32_swap_b32 v25, v2
    s_nop 0
    v_max_f32 v25, v25, v2
    v_mul_f32 v26, s40, v25
    v_fma_f32 v3, v23, s40, -v26
    v_exp_f32 v3, v3
    v_mov_b32 v23, v25
    v_fma_f32 v96, v96, s40, -v26
    v_fma_f32 v97, v97, s40, -v26
    v_fma_f32 v98, v98, s40, -v26
    v_fma_f32 v99, v99, s40, -v26
    v_fma_f32 v100, v100, s40, -v26
    v_fma_f32 v101, v101, s40, -v26
    v_fma_f32 v102, v102, s40, -v26
    v_fma_f32 v103, v103, s40, -v26
    v_fma_f32 v104, v104, s40, -v26
    v_fma_f32 v105, v105, s40, -v26
    v_fma_f32 v106, v106, s40, -v26
    v_fma_f32 v107, v107, s40, -v26
    v_fma_f32 v108, v108, s40, -v26
    v_fma_f32 v109, v109, s40, -v26
    v_fma_f32 v110, v110, s40, -v26
    v_fma_f32 v111, v111, s40, -v26
    v_fma_f32 v112, v112, s40, -v26
    v_fma_f32 v113, v113, s40, -v26
    v_fma_f32 v114, v114, s40, -v26
    v_fma_f32 v115, v115, s40, -v26
    v_fma_f32 v116, v116, s40, -v26
    v_fma_f32 v117, v117, s40, -v26
    v_fma_f32 v118, v118, s40, -v26
    v_fma_f32 v119, v119, s40, -v26
    v_fma_f32 v120, v120, s40, -v26
    v_fma_f32 v121, v121, s40, -v26
    v_fma_f32 v122, v122, s40, -v26
    v_fma_f32 v123, v123, s40, -v26
    v_fma_f32 v124, v124, s40, -v26
    v_fma_f32 v125, v125, s40, -v26
    v_fma_f32 v126, v126, s40, -v26
    v_fma_f32 v127, v127, s40, -v26
    v_fma_f32 v128, v128, s40, -v26
    v_fma_f32 v129, v129, s40, -v26
    v_fma_f32 v130, v130, s40, -v26
    v_fma_f32 v131, v131, s40, -v26
    v_fma_f32 v132, v132, s40, -v26
    v_fma_f32 v133, v133, s40, -v26
    v_fma_f32 v134, v134, s40, -v26
    v_fma_f32 v135, v135, s40, -v26
    v_fma_f32 v136, v136, s40, -v26
    v_fma_f32 v137, v137, s40, -v26
    v_fma_f32 v138, v138, s40, -v26
    v_fma_f32 v139, v139, s40, -v26
    v_fma_f32 v140, v140, s40, -v26
    v_fma_f32 v141, v141, s40, -v26
    v_fma_f32 v142, v142, s40, -v26
    v_fma_f32 v143, v143, s40, -v26
    v_fma_f32 v144, v144, s40, -v26
    v_fma_f32 v145, v145, s40, -v26
    v_fma_f32 v146, v146, s40, -v26
    v_fma_f32 v147, v147, s40, -v26
    v_fma_f32 v148, v148, s40, -v26
    v_fma_f32 v149, v149, s40, -v26
    v_fma_f32 v150, v150, s40, -v26
    v_fma_f32 v151, v151, s40, -v26
    v_fma_f32 v152, v152, s40, -v26
    v_fma_f32 v153, v153, s40, -v26
    v_fma_f32 v154, v154, s40, -v26
    v_fma_f32 v155, v155, s40, -v26
    v_fma_f32 v156, v156, s40, -v26
    v_fma_f32 v157, v157, s40, -v26
    v_fma_f32 v158, v158, s40, -v26
    v_fma_f32 v159, v159, s40, -v26
    v_exp_f32 v96, v96
    v_exp_f32 v97, v97
    v_exp_f32 v98, v98
    v_exp_f32 v99, v99
    v_exp_f32 v100, v100
    v_exp_f32 v101, v101
    v_exp_f32 v102, v102
    v_exp_f32 v103, v103
    v_exp_f32 v104, v104
    v_exp_f32 v105, v105
    v_exp_f32 v106, v106
    v_exp_f32 v107, v107
    v_exp_f32 v108, v108
    v_exp_f32 v109, v109
    v_exp_f32 v110, v110
    v_exp_f32 v111, v111
    v_exp_f32 v112, v112
    v_exp_f32 v113, v113
    v_exp_f32 v114, v114
    v_exp_f32 v115, v115
    v_exp_f32 v116, v116
    v_exp_f32 v117, v117
    v_exp_f32 v118, v118
    v_exp_f32 v119, v119
    v_exp_f32 v120, v120
    v_exp_f32 v121, v121
    v_exp_f32 v122, v122
    v_exp_f32 v123, v123
    v_exp_f32 v124, v124
    v_exp_f32 v125, v125
    v_exp_f32 v126, v126
    v_exp_f32 v127, v127
    v_exp_f32 v128, v128
    v_exp_f32 v129, v129
    v_exp_f32 v130, v130
    v_exp_f32 v131, v131
    v_exp_f32 v132, v132
    v_exp_f32 v133, v133
    v_exp_f32 v134, v134
    v_exp_f32 v135, v135
    v_exp_f32 v136, v136
    v_exp_f32 v137, v137
    v_exp_f32 v138, v138
    v_exp_f32 v139, v139
    v_exp_f32 v140, v140
    v_exp_f32 v141, v141
    v_exp_f32 v142, v142
    v_exp_f32 v143, v143
    v_exp_f32 v144, v144
    v_exp_f32 v145, v145
    v_exp_f32 v146, v146
    v_exp_f32 v147, v147
    v_exp_f32 v148, v148
    v_exp_f32 v149, v149
    v_exp_f32 v150, v150
    v_exp_f32 v151, v151
    v_exp_f32 v152, v152
    v_exp_f32 v153, v153
    v_exp_f32 v154, v154
    v_exp_f32 v155, v155
    v_exp_f32 v156, v156
    v_exp_f32 v157, v157
    v_exp_f32 v158, v158
    v_exp_f32 v159, v159
    v_mul_f32 v160, v160, v3
    v_mul_f32 v161, v161, v3
    v_mul_f32 v162, v162, v3
    v_mul_f32 v163, v163, v3
    v_mul_f32 v164, v164, v3
    v_mul_f32 v165, v165, v3
    v_mul_f32 v166, v166, v3
    v_mul_f32 v167, v167, v3
    v_mul_f32 v168, v168, v3
    v_mul_f32 v169, v169, v3
    v_mul_f32 v170, v170, v3
    v_mul_f32 v171, v171, v3
    v_mul_f32 v172, v172, v3
    v_mul_f32 v173, v173, v3
    v_mul_f32 v174, v174, v3
    v_mul_f32 v175, v175, v3
    v_mul_f32 v176, v176, v3
    v_mul_f32 v177, v177, v3
    v_mul_f32 v178, v178, v3
    v_mul_f32 v179, v179, v3
    v_mul_f32 v180, v180, v3
    v_mul_f32 v181, v181, v3
    v_mul_f32 v182, v182, v3
    v_mul_f32 v183, v183, v3
    v_mul_f32 v184, v184, v3
    v_mul_f32 v185, v185, v3
    v_mul_f32 v186, v186, v3
    v_mul_f32 v187, v187, v3
    v_mul_f32 v188, v188, v3
    v_mul_f32 v189, v189, v3
    v_mul_f32 v190, v190, v3
    v_mul_f32 v191, v191, v3
    v_mul_f32 v192, v192, v3
    v_mul_f32 v193, v193, v3
    v_mul_f32 v194, v194, v3
    v_mul_f32 v195, v195, v3
    v_mul_f32 v196, v196, v3
    v_mul_f32 v197, v197, v3
    v_mul_f32 v198, v198, v3
    v_mul_f32 v199, v199, v3
    v_mul_f32 v200, v200, v3
    v_mul_f32 v201, v201, v3
    v_mul_f32 v202, v202, v3
    v_mul_f32 v203, v203, v3
    v_mul_f32 v204, v204, v3
    v_mul_f32 v205, v205, v3
    v_mul_f32 v206, v206, v3
    v_mul_f32 v207, v207, v3
    v_mul_f32 v208, v208, v3
    v_mul_f32 v209, v209, v3
    v_mul_f32 v210, v210, v3
    v_mul_f32 v211, v211, v3
    v_mul_f32 v212, v212, v3
    v_mul_f32 v213, v213, v3
    v_mul_f32 v214, v214, v3
    v_mul_f32 v215, v215, v3
    v_mul_f32 v216, v216, v3
    v_mul_f32 v217, v217, v3
    v_mul_f32 v218, v218, v3
    v_mul_f32 v219, v219, v3
    v_mul_f32 v220, v220, v3
    v_mul_f32 v221, v221, v3
    v_mul_f32 v222, v222, v3
    v_mul_f32 v223, v223, v3
    v_add_f32 v4, v96, v97
    v_add_f32 v2, v98, v99
    v_add_f32 v4, v4, v100
    v_add_f32 v2, v2, v101
    v_add_f32 v4, v4, v102
    v_add_f32 v2, v2, v103
    v_add_f32 v4, v4, v104
    v_add_f32 v2, v2, v105
    v_add_f32 v4, v4, v106
    v_add_f32 v2, v2, v107
    v_add_f32 v4, v4, v108
    v_add_f32 v2, v2, v109
    v_add_f32 v4, v4, v110
    v_add_f32 v2, v2, v111
    v_add_f32 v4, v4, v112
    v_add_f32 v2, v2, v113
    v_add_f32 v4, v4, v114
    v_add_f32 v2, v2, v115
    v_add_f32 v4, v4, v116
    v_add_f32 v2, v2, v117
    v_add_f32 v4, v4, v118
    v_add_f32 v2, v2, v119
    v_add_f32 v4, v4, v120
    v_add_f32 v2, v2, v121
    v_add_f32 v4, v4, v122
    v_add_f32 v2, v2, v123
    v_add_f32 v4, v4, v124
    v_add_f32 v2, v2, v125
    v_add_f32 v4, v4, v126
    v_add_f32 v2, v2, v127
    v_add_f32 v4, v4, v128
    v_add_f32 v2, v2, v129
    v_add_f32 v4, v4, v130
    v_add_f32 v2, v2, v131
    v_add_f32 v4, v4, v132
    v_add_f32 v2, v2, v133
    v_add_f32 v4, v4, v134
    v_add_f32 v2, v2, v135
    v_add_f32 v4, v4, v136
    v_add_f32 v2, v2, v137
    v_add_f32 v4, v4, v138
    v_add_f32 v2, v2, v139
    v_add_f32 v4, v4, v140
    v_add_f32 v2, v2, v141
    v_add_f32 v4, v4, v142
    v_add_f32 v2, v2, v143
    v_add_f32 v4, v4, v144
    v_add_f32 v2, v2, v145
    v_add_f32 v4, v4, v146
    v_add_f32 v2, v2, v147
    v_add_f32 v4, v4, v148
    v_add_f32 v2, v2, v149
    v_add_f32 v4, v4, v150
    v_add_f32 v2, v2, v151
    v_add_f32 v4, v4, v152
    v_add_f32 v2, v2, v153
    v_add_f32 v4, v4, v154
    v_add_f32 v2, v2, v155
    v_add_f32 v4, v4, v156
    v_add_f32 v2, v2, v157
    v_add_f32 v4, v4, v158
    v_add_f32 v2, v2, v159
    v_cvt_pk_bf16_f32 v96, v96, v97
    v_cvt_pk_bf16_f32 v97, v98, v99
    v_cvt_pk_bf16_f32 v98, v100, v101
    v_cvt_pk_bf16_f32 v99, v102, v103
    v_cvt_pk_bf16_f32 v100, v104, v105
    v_cvt_pk_bf16_f32 v101, v106, v107
    v_cvt_pk_bf16_f32 v102, v108, v109
    v_cvt_pk_bf16_f32 v103, v110, v111
    v_cvt_pk_bf16_f32 v104, v112, v113
    v_cvt_pk_bf16_f32 v105, v114, v115
    v_cvt_pk_bf16_f32 v106, v116, v117
    v_cvt_pk_bf16_f32 v107, v118, v119
    v_cvt_pk_bf16_f32 v108, v120, v121
    v_cvt_pk_bf16_f32 v109, v122, v123
    v_cvt_pk_bf16_f32 v110, v124, v125
    v_cvt_pk_bf16_f32 v111, v126, v127
    v_cvt_pk_bf16_f32 v112, v128, v129
    v_cvt_pk_bf16_f32 v113, v130, v131
    v_cvt_pk_bf16_f32 v114, v132, v133
    v_cvt_pk_bf16_f32 v115, v134, v135
    v_cvt_pk_bf16_f32 v116, v136, v137
    v_cvt_pk_bf16_f32 v117, v138, v139
    v_cvt_pk_bf16_f32 v118, v140, v141
    v_cvt_pk_bf16_f32 v119, v142, v143
    v_cvt_pk_bf16_f32 v120, v144, v145
    v_cvt_pk_bf16_f32 v121, v146, v147
    v_cvt_pk_bf16_f32 v122, v148, v149
    v_cvt_pk_bf16_f32 v123, v150, v151
    v_cvt_pk_bf16_f32 v124, v152, v153
    v_cvt_pk_bf16_f32 v125, v154, v155
    v_cvt_pk_bf16_f32 v126, v156, v157
    v_cvt_pk_bf16_f32 v127, v158, v159
    v_add_f32 v4, v4, v2
    v_fma_f32 v24, v24, v3, v4
    s_waitcnt vmcnt(8)
    s_add_u32 s78, s78, 1
    s_waitcnt lgkmcnt(0)
    v_mov_b32 v5, 1
    s_mov_b64 exec, 1
    ds_add_u32 v29, v5
    s_mov_b64 exec, -1
gb23:
    ds_read_b32 v5, v29
    s_waitcnt lgkmcnt(0)
    v_readfirstlane_b32 s31, v5
    s_lshl_b32 s30, s78, 2
    s_nop 1
    s_cmp_ge_u32 s31, s30
    s_cbranch_scc1 gb23_ok
    s_sleep 0
    s_branch gb23
gb23_ok:
    ds_read_b64_tr_b16 v[128:129], v19 offset:32768
    ds_read_b64_tr_b16 v[130:131], v19 offset:34816
    ds_read_b64_tr_b16 v[132:133], v19 offset:36864
    ds_read_b64_tr_b16 v[134:135], v19 offset:38912
    ds_read_b64_tr_b16 v[136:137], v20 offset:32768
    ds_read_b64_tr_b16 v[138:139], v20 offset:34816
    ds_read_b64_tr_b16 v[140:141], v20 offset:36864
    ds_read_b64_tr_b16 v[142:143], v20 offset:38912
    ds_read_b64_tr_b16 v[144:145], v21 offset:32768
    ds_read_b64_tr_b16 v[146:147], v21 offset:34816
    ds_read_b64_tr_b16 v[148:149], v21 offset:36864
    ds_read_b64_tr_b16 v[150:151], v21 offset:38912
    ds_read_b64_tr_b16 v[152:153], v22 offset:32768
    ds_read_b64_tr_b16 v[154:155], v22 offset:34816
    ds_read_b64_tr_b16 v[156:157], v22 offset:36864
    ds_read_b64_tr_b16 v[158:159], v22 offset:38912
    s_waitcnt lgkmcnt(0)
    ds_read_b64_tr_b16 v[32:33], v19 offset:40960
    ds_read_b64_tr_b16 v[34:35], v19 offset:43008
    ds_read_b64_tr_b16 v[36:37], v19 offset:45056
    ds_read_b64_tr_b16 v[38:39], v19 offset:47104
    ds_read_b64_tr_b16 v[40:41], v20 offset:40960
    ds_read_b64_tr_b16 v[42:43], v20 offset:43008
    ds_read_b64_tr_b16 v[44:45], v20 offset:45056
    ds_read_b64_tr_b16 v[46:47], v20 offset:47104
    ds_read_b64_tr_b16 v[48:49], v21 offset:40960
    ds_read_b64_tr_b16 v[50:51], v21 offset:43008
    ds_read_b64_tr_b16 v[52:53], v21 offset:45056
    ds_read_b64_tr_b16 v[54:55], v21 offset:47104
    ds_read_b64_tr_b16 v[56:57], v22 offset:40960
    ds_read_b64_tr_b16 v[58:59], v22 offset:43008
    ds_read_b64_tr_b16 v[60:61], v22 offset:45056
    ds_read_b64_tr_b16 v[62:63], v22 offset:47104
    v_mfma_f32_32x32x16_bf16 v[160:175], v[128:131], v[96:99], v[160:175]
    v_mfma_f32_32x32x16_bf16 v[176:191], v[136:139], v[96:99], v[176:191]
    v_mfma_f32_32x32x16_bf16 v[192:207], v[144:147], v[96:99], v[192:207]
    v_mfma_f32_32x32x16_bf16 v[208:223], v[152:155], v[96:99], v[208:223]
    v_mfma_f32_32x32x16_bf16 v[160:175], v[132:135], v[100:103], v[160:175]
    v_mfma_f32_32x32x16_bf16 v[176:191], v[140:143], v[100:103], v[176:191]
    v_mfma_f32_32x32x16_bf16 v[192:207], v[148:151], v[100:103], v[192:207]
    v_mfma_f32_32x32x16_bf16 v[208:223], v[156:159], v[100:103], v[208:223]
    s_waitcnt lgkmcnt(0)
    ds_read_b64_tr_b16 v[128:129], v19 offset:49152
    ds_read_b64_tr_b16 v[130:131], v19 offset:51200
    ds_read_b64_tr_b16 v[132:133], v19 offset:53248
    ds_read_b64_tr_b16 v[134:135], v19 offset:55296
    ds_read_b64_tr_b16 v[136:137], v20 offset:49152
    ds_read_b64_tr_b16 v[138:139], v20 offset:51200
    ds_read_b64_tr_b16 v[140:141], v20 offset:53248
    ds_read_b64_tr_b16 v[142:143], v20 offset:55296
    ds_read_b64_tr_b16 v[144:145], v21 offset:49152
    ds_read_b64_tr_b16 v[146:147], v21 offset:51200
    ds_read_b64_tr_b16 v[148:149], v21 offset:53248
    ds_read_b64_tr_b16 v[150:151], v21 offset:55296
    ds_read_b64_tr_b16 v[152:153], v22 offset:49152
    ds_read_b64_tr_b16 v[154:155], v22 offset:51200
    ds_read_b64_tr_b16 v[156:157], v22 offset:53248
    ds_read_b64_tr_b16 v[158:159], v22 offset:55296
    v_mfma_f32_32x32x16_bf16 v[160:175], v[32:35], v[104:107], v[160:175]
    v_mfma_f32_32x32x16_bf16 v[176:191], v[40:43], v[104:107], v[176:191]
    v_mfma_f32_32x32x16_bf16 v[192:207], v[48:51], v[104:107], v[192:207]
    v_mfma_f32_32x32x16_bf16 v[208:223], v[56:59], v[104:107], v[208:223]
    v_mfma_f32_32x32x16_bf16 v[160:175], v[36:39], v[108:111], v[160:175]
    v_mfma_f32_32x32x16_bf16 v[176:191], v[44:47], v[108:111], v[176:191]
    v_mfma_f32_32x32x16_bf16 v[192:207], v[52:55], v[108:111], v[192:207]
    v_mfma_f32_32x32x16_bf16 v[208:223], v[60:63], v[108:111], v[208:223]
    s_waitcnt lgkmcnt(0)
    ds_read_b64_tr_b16 v[32:33], v19 offset:57344
    ds_read_b64_tr_b16 v[34:35], v19 offset:59392
    ds_read_b64_tr_b16 v[36:37], v19 offset:61440
    ds_read_b64_tr_b16 v[38:39], v19 offset:63488
    ds_read_b64_tr_b16 v[40:41], v20 offset:57344
    ds_read_b64_tr_b16 v[42:43], v20 offset:59392
    ds_read_b64_tr_b16 v[44:45], v20 offset:61440
    ds_read_b64_tr_b16 v[46:47], v20 offset:63488
    ds_read_b64_tr_b16 v[48:49], v21 offset:57344
    ds_read_b64_tr_b16 v[50:51], v21 offset:59392
    ds_read_b64_tr_b16 v[52:53], v21 offset:61440
    ds_read_b64_tr_b16 v[54:55], v21 offset:63488
    ds_read_b64_tr_b16 v[56:57], v22 offset:57344
    ds_read_b64_tr_b16 v[58:59], v22 offset:59392
    ds_read_b64_tr_b16 v[60:61], v22 offset:61440
    ds_read_b64_tr_b16 v[62:63], v22 offset:63488
    v_mfma_f32_32x32x16_bf16 v[160:175], v[128:131], v[112:115], v[160:175]
    v_mfma_f32_32x32x16_bf16 v[176:191], v[136:139], v[112:115], v[176:191]
    v_mfma_f32_32x32x16_bf16 v[192:207], v[144:147], v[112:115], v[192:207]
    v_mfma_f32_32x32x16_bf16 v[208:223], v[152:155], v[112:115], v[208:223]
    v_mfma_f32_32x32x16_bf16 v[160:175], v[132:135], v[116:119], v[160:175]
    v_mfma_f32_32x32x16_bf16 v[176:191], v[140:143], v[116:119], v[176:191]
    v_mfma_f32_32x32x16_bf16 v[192:207], v[148:151], v[116:119], v[192:207]
    v_mfma_f32_32x32x16_bf16 v[208:223], v[156:159], v[116:119], v[208:223]
    s_waitcnt lgkmcnt(0)
    s_add_u32 s78, s78, 1
    s_waitcnt lgkmcnt(0)
    v_mov_b32 v5, 1
    s_mov_b64 exec, 1
    ds_add_u32 v29, v5
    s_mov_b64 exec, -1
gb24:
    ds_read_b32 v5, v29
    s_waitcnt lgkmcnt(0)
    v_readfirstlane_b32 s31, v5
    s_lshl_b32 s30, s78, 2
    s_nop 1
    s_cmp_ge_u32 s31, s30
    s_cbranch_scc1 gb24_ok
    s_sleep 0
    s_branch gb24
gb24_ok:
    s_mov_b32 m0, s42
    s_mov_b32 s28, s44
    buffer_load_dwordx4 v10, s[20:23], s28 offen offset:0  lds
    buffer_load_dwordx4 v10, s[20:23], s28 offen offset:1024  lds
    buffer_load_dwordx4 v10, s[20:23], s28 offen offset:2048  lds
    buffer_load_dwordx4 v10, s[20:23], s28 offen offset:3072  lds
    s_add_u32 m0, s42, 4096
    s_add_u32 s28, s28, 4096
    buffer_load_dwordx4 v10, s[20:23], s28 offen offset:0  lds
    buffer_load_dwordx4 v10, s[20:23], s28 offen offset:1024  lds
    buffer_load_dwordx4 v10, s[20:23], s28 offen offset:2048  lds
    buffer_load_dwordx4 v10, s[20:23], s28 offen offset:3072  lds
    v_mfma_f32_32x32x16_bf16 v[160:175], v[32:35], v[120:123], v[160:175]
    v_mfma_f32_32x32x16_bf16 v[176:191], v[40:43], v[120:123], v[176:191]
    v_mfma_f32_32x32x16_bf16 v[192:207], v[48:51], v[120:123], v[192:207]
    v_mfma_f32_32x32x16_bf16 v[208:223], v[56:59], v[120:123], v[208:223]
    v_mfma_f32_32x32x16_bf16 v[160:175], v[36:39], v[124:127], v[160:175]
    v_mfma_f32_32x32x16_bf16 v[176:191], v[44:47], v[124:127], v[176:191]
    v_mfma_f32_32x32x16_bf16 v[192:207], v[52:55], v[124:127], v[192:207]
    v_mfma_f32_32x32x16_bf16 v[208:223], v[60:63], v[124:127], v[208:223]
    s_mov_b32 s38, s44
    s_add_u32 s39, s39, 1
    s_cmp_lt_u32 s39, 4
    s_cbranch_scc1 concat_heads__gqa_block_cached__mha_block_cached__near_ridge_kernel_chunk
    v_mov_b32 v2, v24
    s_nop 1
    v_permlane32_swap_b32 v24, v2
    s_nop 0
    v_add_f32 v24, v24, v2
    v_rcp_f32 v26, v24
    s_nop 7
    v_mul_f32 v160, v160, v26
    v_mul_f32 v161, v161, v26
    v_mul_f32 v162, v162, v26
    v_mul_f32 v163, v163, v26
    v_mul_f32 v164, v164, v26
    v_mul_f32 v165, v165, v26
    v_mul_f32 v166, v166, v26
    v_mul_f32 v167, v167, v26
    v_mul_f32 v168, v168, v26
    v_mul_f32 v169, v169, v26
    v_mul_f32 v170, v170, v26
    v_mul_f32 v171, v171, v26
    v_mul_f32 v172, v172, v26
    v_mul_f32 v173, v173, v26
    v_mul_f32 v174, v174, v26
    v_mul_f32 v175, v175, v26
    v_mul_f32 v176, v176, v26
    v_mul_f32 v177, v177, v26
    v_mul_f32 v178, v178, v26
    v_mul_f32 v179, v179, v26
    v_mul_f32 v180, v180, v26
    v_mul_f32 v181, v181, v26
    v_mul_f32 v182, v182, v26
    v_mul_f32 v183, v183, v26
    v_mul_f32 v184, v184, v26
    v_mul_f32 v185, v185, v26
    v_mul_f32 v186, v186, v26
    v_mul_f32 v187, v187, v26
    v_mul_f32 v188, v188, v26
    v_mul_f32 v189, v189, v26
    v_mul_f32 v190, v190, v26
    v_mul_f32 v191, v191, v26
    v_mul_f32 v192, v192, v26
    v_mul_f32 v193, v193, v26
    v_mul_f32 v194, v194, v26
    v_mul_f32 v195, v195, v26
    v_mul_f32 v196, v196, v26
    v_mul_f32 v197, v197, v26
    v_mul_f32 v198, v198, v26
    v_mul_f32 v199, v199, v26
    v_mul_f32 v200, v200, v26
    v_mul_f32 v201, v201, v26
    v_mul_f32 v202, v202, v26
    v_mul_f32 v203, v203, v26
    v_mul_f32 v204, v204, v26
    v_mul_f32 v205, v205, v26
    v_mul_f32 v206, v206, v26
    v_mul_f32 v207, v207, v26
    v_mul_f32 v208, v208, v26
    v_mul_f32 v209, v209, v26
    v_mul_f32 v210, v210, v26
    v_mul_f32 v211, v211, v26
    v_mul_f32 v212, v212, v26
    v_mul_f32 v213, v213, v26
    v_mul_f32 v214, v214, v26
    v_mul_f32 v215, v215, v26
    v_mul_f32 v216, v216, v26
    v_mul_f32 v217, v217, v26
    v_mul_f32 v218, v218, v26
    v_mul_f32 v219, v219, v26
    v_mul_f32 v220, v220, v26
    v_mul_f32 v221, v221, v26
    v_mul_f32 v222, v222, v26
    v_mul_f32 v223, v223, v26
    v_cvt_pk_bf16_f32 v96, v160, v161
    v_cvt_pk_bf16_f32 v97, v162, v163
    v_cvt_pk_bf16_f32 v98, v164, v165
    v_cvt_pk_bf16_f32 v99, v166, v167
    v_cvt_pk_bf16_f32 v100, v168, v169
    v_cvt_pk_bf16_f32 v101, v170, v171
    v_cvt_pk_bf16_f32 v102, v172, v173
    v_cvt_pk_bf16_f32 v103, v174, v175
    v_cvt_pk_bf16_f32 v104, v176, v177
    v_cvt_pk_bf16_f32 v105, v178, v179
    v_cvt_pk_bf16_f32 v106, v180, v181
    v_cvt_pk_bf16_f32 v107, v182, v183
    v_cvt_pk_bf16_f32 v108, v184, v185
    v_cvt_pk_bf16_f32 v109, v186, v187
    v_cvt_pk_bf16_f32 v110, v188, v189
    v_cvt_pk_bf16_f32 v111, v190, v191
    v_cvt_pk_bf16_f32 v112, v192, v193
    v_cvt_pk_bf16_f32 v113, v194, v195
    v_cvt_pk_bf16_f32 v114, v196, v197
    v_cvt_pk_bf16_f32 v115, v198, v199
    v_cvt_pk_bf16_f32 v116, v200, v201
    v_cvt_pk_bf16_f32 v117, v202, v203
    v_cvt_pk_bf16_f32 v118, v204, v205
    v_cvt_pk_bf16_f32 v119, v206, v207
    v_cvt_pk_bf16_f32 v120, v208, v209
    v_cvt_pk_bf16_f32 v121, v210, v211
    v_cvt_pk_bf16_f32 v122, v212, v213
    v_cvt_pk_bf16_f32 v123, v214, v215
    v_cvt_pk_bf16_f32 v124, v216, v217
    v_cvt_pk_bf16_f32 v125, v218, v219
    v_cvt_pk_bf16_f32 v126, v220, v221
    v_cvt_pk_bf16_f32 v127, v222, v223
    s_waitcnt vmcnt(0)
    s_lshl_b32 s28, s84, 18
    s_lshl_b32 s29, s85, 2
    s_add_u32 s29, s29, s4
    s_lshl_b32 s29, s29, 13
    s_add_u32 s28, s28, s29
    buffer_store_dwordx4 v[96:99], v1, s[24:27], s28 offen offset:0 sc1
    buffer_store_dwordx4 v[100:103], v1, s[24:27], s28 offen offset:1024 sc1
    buffer_store_dwordx4 v[104:107], v1, s[24:27], s28 offen offset:2048 sc1
    buffer_store_dwordx4 v[108:111], v1, s[24:27], s28 offen offset:3072 sc1
    s_add_u32 s28, s28, 4096
    buffer_store_dwordx4 v[112:115], v1, s[24:27], s28 offen offset:0 sc1
    buffer_store_dwordx4 v[116:119], v1, s[24:27], s28 offen offset:1024 sc1
    buffer_store_dwordx4 v[120:123], v1, s[24:27], s28 offen offset:2048 sc1
    buffer_store_dwordx4 v[124:127], v1, s[24:27], s28 offen offset:3072 sc1
concat_heads__gqa_block_cached__mha_block_cached__near_ridge_kernel_end:
    s_waitcnt vmcnt(0)
    s_setprio 0
    s_barrier
    s_cmp_lg_u32 s79, 0
    s_cbranch_scc1 concat_heads__gqa_block_cached__mha_block_cached__near_ridge_kernel_noflag
    s_lshr_b32 s30, s6, 4
    s_and_b32 s44, s6, 15
    s_lshl_b32 s44, s44, 2
    v_mov_b32 v2, 0
    v_cmp_eq_u32 vcc, 0, v0
    s_lshr_b32 s30, s6, 4
    s_lshl_b32 s28, s7, 1
    s_add_u32 s28, s28, s30
    s_add_u32 s28, s28, 16
    s_lshl_b32 s28, s28, 8
    s_add_u32 s28, s28, 55574528
    s_add_u32 s28, s28, s44
    v_mov_b32 v3, s82
    s_and_saveexec_b64 s[30:31], vcc
    buffer_store_dword v3, v2, s[24:27], s28 offen offset:64 sc1
    s_mov_b64 exec, s[30:31]
    s_lshr_b32 s30, s6, 4
    s_lshl_b32 s28, s7, 1
    s_add_u32 s28, s28, s30
    s_lshl_b32 s28, s28, 8
    s_add_u32 s28, s28, 55574528
    s_add_u32 s28, s28, s44
    v_mov_b32 v3, s83
    s_and_saveexec_b64 s[30:31], vcc
    buffer_store_dword v3, v2, s[24:27], s28 offen offset:64 sc1
    s_mov_b64 exec, s[30:31]
concat_heads__gqa_block_cached__mha_block_cached__near_ridge_kernel_noflag:
    s_mov_b32 s92, s24
    s_mov_b32 s93, s25
    s_mov_b32 s100, s79
    s_load_dwordx2 s[32:33], s[0:1], 32
    s_load_dwordx2 s[34:35], s[0:1], 72
    s_load_dwordx2 s[36:37], s[0:1], 80
    s_load_dwordx2 s[38:39], s[0:1], 96
    s_mov_b32 s4, s100
    s_and_b32 s25, s2, 7
    s_lshr_b32 s26, s2, 3
    s_lshr_b32 s28, s25, 2
    s_bfe_u32 s59, s25, 0x10001
    s_lshr_b32 s27, s26, 2
    s_mov_b32 s29, s27
    s_mov_b32 s43, s27
    s_and_b32 s27, s26, 3
    s_add_u32 s43, s43, s27
    s_and_b32 s43, s43, 3
    s_lshl_b32 s27, s27, 7
    s_and_b32 s30, s25, 1
    s_lshl_b32 s30, s30, 9
    s_add_u32 s30, s30, s27
    s_and_b32 s64, s25, 1
    s_lshl_b32 s27, s28, 1
    s_add_u32 s64, s64, s27
    s_lshl_b32 s64, s64, 5
    s_add_u32 s64, s64, s26
    v_lshlrev_b32 v1, 4, v0
    s_waitcnt lgkmcnt(0)
    s_cmp_ge_u32 s4, 4
    s_cbranch_scc1 concat_heads__gqa_block_cached__mha_block_cached__near_ridge_kernel_p_loader
    s_mov_b32 s60, s38
    s_and_b32 s61, s39, 0xffff
    s_mov_b32 s62, 100663296
    s_mov_b32 s63, 0x20000
    s_lshl_b32 s66, s64, 8
    s_add_u32 s66, s66, 51380224
    v_mov_b32 v4, 0
    buffer_load_dword v7, v4, s[60:63], s66 offen sc0 sc1
    s_mov_b32 s16, s36
    s_and_b32 s17, s37, 0xffff
    s_mov_b32 s18, 4194304
    s_mov_b32 s19, 0x20000
    s_lshr_b32 s25, s4, 1
    s_lshl_b32 s25, s25, 13
    v_add_u32 v2, s25, v1
    v_bfe_u32 v4, v0, 2, 2
    v_lshlrev_b32 v8, 6, v4
    v_bfe_u32 v5, v0, 4, 1
    v_lshlrev_b32 v5, 5, v5
    v_add_u32 v8, v8, v5
    v_and_b32 v5, 1, v0
    v_lshlrev_b32 v5, 4, v5
    v_add_u32 v8, v8, v5
    v_bfe_u32 v5, v0, 1, 1
    v_lshlrev_b32 v5, 3, v5
    v_add_u32 v8, v8, v5
    v_lshrrev_b32 v5, 5, v0
    v_lshlrev_b32 v5, 3, v5
    v_add_u32 v5, v5, v4
    v_lshlrev_b32 v5, 8, v5
    v_add_u32 v8, v8, v5
    v_add_u32 v8, 65536, v8
    s_and_b32 s25, s4, 1
    s_lshl_b32 s25, s25, 7
    v_xor_b32 v8, s25, v8
    v_xor_b32 v9, 64, v8
    v_and_b32 v6, 31, v0
    v_lshlrev_b32 v6, 12, v6
    v_lshrrev_b32 v4, 5, v0
    v_lshlrev_b32 v4, 4, v4
    v_add_u32 v6, v6, v4
    v_add_u32 v6, s25, v6
    s_mov_b32 s23, 0
    s_mov_b32 s56, 0
    s_mov_b32 s24, 0
    v_mov_b32 v16, 0
    v_mov_b32 v17, 0
    v_mov_b32 v18, 0
    v_mov_b32 v19, 0
    v_mov_b32 v20, 0
    v_mov_b32 v21, 0
    v_mov_b32 v22, 0
    v_mov_b32 v23, 0
    v_mov_b32 v24, 0
    v_mov_b32 v25, 0
    v_mov_b32 v26, 0
    v_mov_b32 v27, 0
    v_mov_b32 v28, 0
    v_mov_b32 v29, 0
    v_mov_b32 v30, 0
    v_mov_b32 v31, 0
    v_mov_b32 v32, 0
    v_mov_b32 v33, 0
    v_mov_b32 v34, 0
    v_mov_b32 v35, 0
    v_mov_b32 v36, 0
    v_mov_b32 v37, 0
    v_mov_b32 v38, 0
    v_mov_b32 v39, 0
    v_mov_b32 v40, 0
    v_mov_b32 v41, 0
    v_mov_b32 v42, 0
    v_mov_b32 v43, 0
    v_mov_b32 v44, 0
    v_mov_b32 v45, 0
    v_mov_b32 v46, 0
    v_mov_b32 v47, 0
    v_mov_b32 v48, 0
    v_mov_b32 v49, 0
    v_mov_b32 v50, 0
    v_mov_b32 v51, 0
    v_mov_b32 v52, 0
    v_mov_b32 v53, 0
    v_mov_b32 v54, 0
    v_mov_b32 v55, 0
    v_mov_b32 v56, 0
    v_mov_b32 v57, 0
    v_mov_b32 v58, 0
    v_mov_b32 v59, 0
    v_mov_b32 v60, 0
    v_mov_b32 v61, 0
    v_mov_b32 v62, 0
    v_mov_b32 v63, 0
    v_mov_b32 v64, 0
    v_mov_b32 v65, 0
    v_mov_b32 v66, 0
    v_mov_b32 v67, 0
    v_mov_b32 v68, 0
    v_mov_b32 v69, 0
    v_mov_b32 v70, 0
    v_mov_b32 v71, 0
    v_mov_b32 v72, 0
    v_mov_b32 v73, 0
    v_mov_b32 v74, 0
    v_mov_b32 v75, 0
    v_mov_b32 v76, 0
    v_mov_b32 v77, 0
    v_mov_b32 v78, 0
    v_mov_b32 v79, 0
    v_mov_b32 v144, 0
    v_mov_b32 v145, 0
    v_mov_b32 v146, 0
    v_mov_b32 v147, 0
    v_mov_b32 v148, 0
    v_mov_b32 v149, 0
    v_mov_b32 v150, 0
    v_mov_b32 v151, 0
    v_mov_b32 v152, 0
    v_mov_b32 v153, 0
    v_mov_b32 v154, 0
    v_mov_b32 v155, 0
    v_mov_b32 v156, 0
    v_mov_b32 v157, 0
    v_mov_b32 v158, 0
    v_mov_b32 v159, 0
    v_mov_b32 v160, 0
    v_mov_b32 v161, 0
    v_mov_b32 v162, 0
    v_mov_b32 v163, 0
    v_mov_b32 v164, 0
    v_mov_b32 v165, 0
    v_mov_b32 v166, 0
    v_mov_b32 v167, 0
    v_mov_b32 v168, 0
    v_mov_b32 v169, 0
    v_mov_b32 v170, 0
    v_mov_b32 v171, 0
    v_mov_b32 v172, 0
    v_mov_b32 v173, 0
    v_mov_b32 v174, 0
    v_mov_b32 v175, 0
    v_mov_b32 v176, 0
    v_mov_b32 v177, 0
    v_mov_b32 v178, 0
    v_mov_b32 v179, 0
    v_mov_b32 v180, 0
    v_mov_b32 v181, 0
    v_mov_b32 v182, 0
    v_mov_b32 v183, 0
    v_mov_b32 v184, 0
    v_mov_b32 v185, 0
    v_mov_b32 v186, 0
    v_mov_b32 v187, 0
    v_mov_b32 v188, 0
    v_mov_b32 v189, 0
    v_mov_b32 v190, 0
    v_mov_b32 v191, 0
    v_mov_b32 v192, 0
    v_mov_b32 v193, 0
    v_mov_b32 v194, 0
    v_mov_b32 v195, 0
    v_mov_b32 v196, 0
    v_mov_b32 v197, 0
    v_mov_b32 v198, 0
    v_mov_b32 v199, 0
    v_mov_b32 v200, 0
    v_mov_b32 v201, 0
    v_mov_b32 v202, 0
    v_mov_b32 v203, 0
    v_mov_b32 v204, 0
    v_mov_b32 v205, 0
    v_mov_b32 v206, 0
    v_mov_b32 v207, 0
    s_waitcnt vmcnt(0)
    s_barrier
concat_heads__gqa_block_cached__mha_block_cached__near_ridge_kernel_p_cloop:
    s_barrier
    v_add_u32 v3, s23, v2
    v_add_u32 v10, s56, v8
    v_add_u32 v11, s56, v9
    s_waitcnt lgkmcnt(0)
    v_mfma_f32_32x32x16_bf16 v[16:31], v[144:147], v[176:179], v[16:31]
    ds_read_b64_tr_b16 v[80:81], v10 offset:0
    ds_read_b64_tr_b16 v[82:83], v10 offset:1024
    v_mfma_f32_32x32x16_bf16 v[32:47], v[160:163], v[176:179], v[32:47]
    ds_read_b64_tr_b16 v[96:97], v11 offset:0
    ds_read_b64_tr_b16 v[98:99], v11 offset:1024
    v_mfma_f32_32x32x16_bf16 v[48:63], v[144:147], v[192:195], v[48:63]
    ds_read_b128 v[112:115], v3 offset:0
    ds_read_b128 v[128:131], v3 offset:4096
    v_mfma_f32_32x32x16_bf16 v[64:79], v[160:163], v[192:195], v[64:79]
    ds_read_b64_tr_b16 v[84:85], v10 offset:4096
    ds_read_b64_tr_b16 v[86:87], v10 offset:5120
    v_mfma_f32_32x32x16_bf16 v[16:31], v[148:151], v[180:183], v[16:31]
    ds_read_b64_tr_b16 v[100:101], v11 offset:4096
    ds_read_b64_tr_b16 v[102:103], v11 offset:5120
    v_mfma_f32_32x32x16_bf16 v[32:47], v[164:167], v[180:183], v[32:47]
    ds_read_b128 v[116:119], v3 offset:1024
    ds_read_b128 v[132:135], v3 offset:5120
    v_mfma_f32_32x32x16_bf16 v[48:63], v[148:151], v[196:199], v[48:63]
    ds_read_b64_tr_b16 v[88:89], v10 offset:8192
    ds_read_b64_tr_b16 v[90:91], v10 offset:9216
    v_mfma_f32_32x32x16_bf16 v[64:79], v[164:167], v[196:199], v[64:79]
    ds_read_b64_tr_b16 v[104:105], v11 offset:8192
    ds_read_b64_tr_b16 v[106:107], v11 offset:9216
    v_mfma_f32_32x32x16_bf16 v[16:31], v[152:155], v[184:187], v[16:31]
    ds_read_b128 v[120:123], v3 offset:2048
    ds_read_b128 v[136:139], v3 offset:6144
    v_mfma_f32_32x32x16_bf16 v[32:47], v[168:171], v[184:187], v[32:47]
    ds_read_b64_tr_b16 v[92:93], v10 offset:12288
    ds_read_b64_tr_b16 v[94:95], v10 offset:13312
    v_mfma_f32_32x32x16_bf16 v[48:63], v[152:155], v[200:203], v[48:63]
    ds_read_b64_tr_b16 v[108:109], v11 offset:12288
    ds_read_b64_tr_b16 v[110:111], v11 offset:13312
    v_mfma_f32_32x32x16_bf16 v[64:79], v[168:171], v[200:203], v[64:79]
    ds_read_b128 v[124:127], v3 offset:3072
    ds_read_b128 v[140:143], v3 offset:7168
    v_mfma_f32_32x32x16_bf16 v[16:31], v[156:159], v[188:191], v[16:31]
    s_add_u32 s23, s23, 16384
    s_and_b32 s23, s23, 65535
    s_add_u32 s56, s56, 16384
    v_mfma_f32_32x32x16_bf16 v[32:47], v[172:175], v[188:191], v[32:47]
    s_cmp_eq_u32 s56, 98304
    s_cselect_b32 s56, 0, s56
    s_add_u32 s24, s24, 1
    v_mfma_f32_32x32x16_bf16 v[48:63], v[156:159], v[204:207], v[48:63]
    v_mfma_f32_32x32x16_bf16 v[64:79], v[172:175], v[204:207], v[64:79]
    s_barrier
    v_add_u32 v3, s23, v2
    v_add_u32 v10, s56, v8
    v_add_u32 v11, s56, v9
    s_waitcnt lgkmcnt(0)
    v_mfma_f32_32x32x16_bf16 v[16:31], v[80:83], v[112:115], v[16:31]
    ds_read_b64_tr_b16 v[144:145], v10 offset:0
    ds_read_b64_tr_b16 v[146:147], v10 offset:1024
    v_mfma_f32_32x32x16_bf16 v[32:47], v[96:99], v[112:115], v[32:47]
    ds_read_b64_tr_b16 v[160:161], v11 offset:0
    ds_read_b64_tr_b16 v[162:163], v11 offset:1024
    v_mfma_f32_32x32x16_bf16 v[48:63], v[80:83], v[128:131], v[48:63]
    ds_read_b128 v[176:179], v3 offset:0
    ds_read_b128 v[192:195], v3 offset:4096
    v_mfma_f32_32x32x16_bf16 v[64:79], v[96:99], v[128:131], v[64:79]
    ds_read_b64_tr_b16 v[148:149], v10 offset:4096
    ds_read_b64_tr_b16 v[150:151], v10 offset:5120
    v_mfma_f32_32x32x16_bf16 v[16:31], v[84:87], v[116:119], v[16:31]
    ds_read_b64_tr_b16 v[164:165], v11 offset:4096
    ds_read_b64_tr_b16 v[166:167], v11 offset:5120
    v_mfma_f32_32x32x16_bf16 v[32:47], v[100:103], v[116:119], v[32:47]
    ds_read_b128 v[180:183], v3 offset:1024
    ds_read_b128 v[196:199], v3 offset:5120
    v_mfma_f32_32x32x16_bf16 v[48:63], v[84:87], v[132:135], v[48:63]
    ds_read_b64_tr_b16 v[152:153], v10 offset:8192
    ds_read_b64_tr_b16 v[154:155], v10 offset:9216
    v_mfma_f32_32x32x16_bf16 v[64:79], v[100:103], v[132:135], v[64:79]
    ds_read_b64_tr_b16 v[168:169], v11 offset:8192
    ds_read_b64_tr_b16 v[170:171], v11 offset:9216
    v_mfma_f32_32x32x16_bf16 v[16:31], v[88:91], v[120:123], v[16:31]
    ds_read_b128 v[184:187], v3 offset:2048
    ds_read_b128 v[200:203], v3 offset:6144
    v_mfma_f32_32x32x16_bf16 v[32:47], v[104:107], v[120:123], v[32:47]
    ds_read_b64_tr_b16 v[156:157], v10 offset:12288
    ds_read_b64_tr_b16 v[158:159], v10 offset:13312
    v_mfma_f32_32x32x16_bf16 v[48:63], v[88:91], v[136:139], v[48:63]
    ds_read_b64_tr_b16 v[172:173], v11 offset:12288
    ds_read_b64_tr_b16 v[174:175], v11 offset:13312
    v_mfma_f32_32x32x16_bf16 v[64:79], v[104:107], v[136:139], v[64:79]
    ds_read_b128 v[188:191], v3 offset:3072
    ds_read_b128 v[204:207], v3 offset:7168
    v_mfma_f32_32x32x16_bf16 v[16:31], v[92:95], v[124:127], v[16:31]
    s_add_u32 s23, s23, 16384
    s_and_b32 s23, s23, 65535
    s_add_u32 s56, s56, 16384
    v_mfma_f32_32x32x16_bf16 v[32:47], v[108:111], v[124:127], v[32:47]
    s_cmp_eq_u32 s56, 98304
    s_cselect_b32 s56, 0, s56
    s_add_u32 s24, s24, 1
    v_mfma_f32_32x32x16_bf16 v[48:63], v[92:95], v[140:143], v[48:63]
    v_mfma_f32_32x32x16_bf16 v[64:79], v[108:111], v[140:143], v[64:79]
    s_cmp_lt_u32 s24, 32
    s_cbranch_scc1 concat_heads__gqa_block_cached__mha_block_cached__near_ridge_kernel_p_cloop
    s_waitcnt lgkmcnt(0)
    v_mfma_f32_32x32x16_bf16 v[16:31], v[144:147], v[176:179], v[16:31]
    v_mfma_f32_32x32x16_bf16 v[32:47], v[160:163], v[176:179], v[32:47]
    v_mfma_f32_32x32x16_bf16 v[48:63], v[144:147], v[192:195], v[48:63]
    v_mfma_f32_32x32x16_bf16 v[64:79], v[160:163], v[192:195], v[64:79]
    v_mfma_f32_32x32x16_bf16 v[16:31], v[148:151], v[180:183], v[16:31]
    v_mfma_f32_32x32x16_bf16 v[32:47], v[164:167], v[180:183], v[32:47]
    v_mfma_f32_32x32x16_bf16 v[48:63], v[148:151], v[196:199], v[48:63]
    v_mfma_f32_32x32x16_bf16 v[64:79], v[164:167], v[196:199], v[64:79]
    v_mfma_f32_32x32x16_bf16 v[16:31], v[152:155], v[184:187], v[16:31]
    v_mfma_f32_32x32x16_bf16 v[32:47], v[168:171], v[184:187], v[32:47]
    v_mfma_f32_32x32x16_bf16 v[48:63], v[152:155], v[200:203], v[48:63]
    v_mfma_f32_32x32x16_bf16 v[64:79], v[168:171], v[200:203], v[64:79]
    v_mfma_f32_32x32x16_bf16 v[16:31], v[156:159], v[188:191], v[16:31]
    v_mfma_f32_32x32x16_bf16 v[32:47], v[172:175], v[188:191], v[32:47]
    v_mfma_f32_32x32x16_bf16 v[48:63], v[156:159], v[204:207], v[48:63]
    v_mfma_f32_32x32x16_bf16 v[64:79], v[172:175], v[204:207], v[64:79]
    s_waitcnt vmcnt(0)
    v_readfirstlane_b32 s65, v7
    s_nop 2
    s_mul_i32 s65, s65, 0x9e3779b1
    s_add_u32 s65, s65, 0x7f4a7c15
    s_bfe_u32 s68, s65, 0x80000
    s_bfe_u32 s69, s65, 0x80008
    s_bfe_u32 s70, s65, 0x80010
    s_bfe_u32 s71, s65, 0x80018
    s_mov_b32 s27, 0xffffff00
    v_mov_b32 v4, s27
    s_lshl_b32 s31, s64, 1
    s_add_u32 s52, s31, s59
    s_xor_b32 s25, s59, 1
    s_add_u32 s31, s31, s25
    s_lshl_b32 s52, s52, 2
    s_add_u32 s52, s52, s4
    s_lshl_b32 s52, s52, 13
    s_add_u32 s52, s52, 67108864
    s_lshl_b32 s31, s31, 2
    s_add_u32 s31, s31, s4
    s_lshl_b32 s31, s31, 13
    s_add_u32 s31, s31, 67108864
    s_cmp_eq_u32 s59, 0
    s_cbranch_scc0 concat_heads__gqa_block_cached__mha_block_cached__near_ridge_kernel_p_x1
    v_and_or_b32 v48, v48, v4, s68
    v_and_or_b32 v49, v49, v4, s69
    v_and_or_b32 v50, v50, v4, s70
    v_and_or_b32 v51, v51, v4, s71
    v_and_or_b32 v52, v52, v4, s68
    v_and_or_b32 v53, v53, v4, s69
    v_and_or_b32 v54, v54, v4, s70
    v_and_or_b32 v55, v55, v4, s71
    v_and_or_b32 v56, v56, v4, s68
    v_and_or_b32 v57, v57, v4, s69
    v_and_or_b32 v58, v58, v4, s70
    v_and_or_b32 v59, v59, v4, s71
    v_and_or_b32 v60, v60, v4, s68
    v_and_or_b32 v61, v61, v4, s69
    v_and_or_b32 v62, v62, v4, s70
    v_and_or_b32 v63, v63, v4, s71
    v_and_or_b32 v64, v64, v4, s68
    v_and_or_b32 v65, v65, v4, s69
    v_and_or_b32 v66, v66, v4, s70
    v_and_or_b32 v67, v67, v4, s71
    v_and_or_b32 v68, v68, v4, s68
    v_and_or_b32 v69, v69, v4, s69
    v_and_or_b32 v70, v70, v4, s70
    v_and_or_b32 v71, v71, v4, s71
    v_and_or_b32 v72, v72, v4, s68
    v_and_or_b32 v73, v73, v4, s69
    v_and_or_b32 v74, v74, v4, s70
    v_and_or_b32 v75, v75, v4, s71
    v_and_or_b32 v76, v76, v4, s68
    v_and_or_b32 v77, v77, v4, s69
    v_and_or_b32 v78, v78, v4, s70
    v_and_or_b32 v79, v79, v4, s71
    s_add_u32 s25, s52, 0
    buffer_store_dwordx4 v[48:51], v1, s[60:63], s25 offen offset:0 sc1
    buffer_store_dwordx4 v[52:55], v1, s[60:63], s25 offen offset:1024 sc1
    buffer_store_dwordx4 v[56:59], v1, s[60:63], s25 offen offset:2048 sc1
    buffer_store_dwordx4 v[60:63], v1, s[60:63], s25 offen offset:3072 sc1
    s_add_u32 s25, s25, 4096
    buffer_store_dwordx4 v[64:67], v1, s[60:63], s25 offen offset:0 sc1
    buffer_store_dwordx4 v[68:71], v1, s[60:63], s25 offen offset:1024 sc1
    buffer_store_dwordx4 v[72:75], v1, s[60:63], s25 offen offset:2048 sc1
    buffer_store_dwordx4 v[76:79], v1, s[60:63], s25 offen offset:3072 sc1
concat_heads__gqa_block_cached__mha_block_cached__near_ridge_kernel_p_poll0:
    s_add_u32 s25, s31, 0
    buffer_load_dwordx4 v[80:83], v1, s[60:63], s25 offen offset:0 sc0 sc1
    buffer_load_dwordx4 v[84:87], v1, s[60:63], s25 offen offset:1024 sc0 sc1
    buffer_load_dwordx4 v[88:91], v1, s[60:63], s25 offen offset:2048 sc0 sc1
    buffer_load_dwordx4 v[92:95], v1, s[60:63], s25 offen offset:3072 sc0 sc1
    s_add_u32 s25, s25, 4096
    buffer_load_dwordx4 v[96:99], v1, s[60:63], s25 offen offset:0 sc0 sc1
    buffer_load_dwordx4 v[100:103], v1, s[60:63], s25 offen offset:1024 sc0 sc1
    buffer_load_dwordx4 v[104:107], v1, s[60:63], s25 offen offset:2048 sc0 sc1
    buffer_load_dwordx4 v[108:111], v1, s[60:63], s25 offen offset:3072 sc0 sc1
    s_waitcnt vmcnt(0)
    v_xor_b32 v5, s68, v80
    v_xor_b32 v3, s69, v81
    v_or_b32 v5, v5, v3
    v_xor_b32 v3, s70, v82
    v_or_b32 v5, v5, v3
    v_xor_b32 v3, s71, v83
    v_or_b32 v5, v5, v3
    v_xor_b32 v3, s68, v84
    v_or_b32 v5, v5, v3
    v_xor_b32 v3, s69, v85
    v_or_b32 v5, v5, v3
    v_xor_b32 v3, s70, v86
    v_or_b32 v5, v5, v3
    v_xor_b32 v3, s71, v87
    v_or_b32 v5, v5, v3
    v_xor_b32 v3, s68, v88
    v_or_b32 v5, v5, v3
    v_xor_b32 v3, s69, v89
    v_or_b32 v5, v5, v3
    v_xor_b32 v3, s70, v90
    v_or_b32 v5, v5, v3
    v_xor_b32 v3, s71, v91
    v_or_b32 v5, v5, v3
    v_xor_b32 v3, s68, v92
    v_or_b32 v5, v5, v3
    v_xor_b32 v3, s69, v93
    v_or_b32 v5, v5, v3
    v_xor_b32 v3, s70, v94
    v_or_b32 v5, v5, v3
    v_xor_b32 v3, s71, v95
    v_or_b32 v5, v5, v3
    v_xor_b32 v3, s68, v96
    v_or_b32 v5, v5, v3
    v_xor_b32 v3, s69, v97
    v_or_b32 v5, v5, v3
    v_xor_b32 v3, s70, v98
    v_or_b32 v5, v5, v3
    v_xor_b32 v3, s71, v99
    v_or_b32 v5, v5, v3
    v_xor_b32 v3, s68, v100
    v_or_b32 v5, v5, v3
    v_xor_b32 v3, s69, v101
    v_or_b32 v5, v5, v3
    v_xor_b32 v3, s70, v102
    v_or_b32 v5, v5, v3
    v_xor_b32 v3, s71, v103
    v_or_b32 v5, v5, v3
    v_xor_b32 v3, s68, v104
    v_or_b32 v5, v5, v3
    v_xor_b32 v3, s69, v105
    v_or_b32 v5, v5, v3
    v_xor_b32 v3, s70, v106
    v_or_b32 v5, v5, v3
    v_xor_b32 v3, s71, v107
    v_or_b32 v5, v5, v3
    v_xor_b32 v3, s68, v108
    v_or_b32 v5, v5, v3
    v_xor_b32 v3, s69, v109
    v_or_b32 v5, v5, v3
    v_xor_b32 v3, s70, v110
    v_or_b32 v5, v5, v3
    v_xor_b32 v3, s71, v111
    v_or_b32 v5, v5, v3
    v_and_b32 v5, 0xff, v5
    v_cmp_ne_u32 vcc, 0, v5
    s_nop 3
    s_cmp_eq_u64 vcc, 0
    s_cbranch_scc1 concat_heads__gqa_block_cached__mha_block_cached__near_ridge_kernel_p_got0
    s_sleep 1
    s_branch concat_heads__gqa_block_cached__mha_block_cached__near_ridge_kernel_p_poll0
concat_heads__gqa_block_cached__mha_block_cached__near_ridge_kernel_p_got0:
    v_add_f32 v16, v16, v80
    v_add_f32 v17, v17, v81
    v_add_f32 v18, v18, v82
    v_add_f32 v19, v19, v83
    v_add_f32 v20, v20, v84
    v_add_f32 v21, v21, v85
    v_add_f32 v22, v22, v86
    v_add_f32 v23, v23, v87
    v_add_f32 v24, v24, v88
    v_add_f32 v25, v25, v89
    v_add_f32 v26, v26, v90
    v_add_f32 v27, v27, v91
    v_add_f32 v28, v28, v92
    v_add_f32 v29, v29, v93
    v_add_f32 v30, v30, v94
    v_add_f32 v31, v31, v95
    v_add_f32 v32, v32, v96
    v_add_f32 v33, v33, v97
    v_add_f32 v34, v34, v98
    v_add_f32 v35, v35, v99
    v_add_f32 v36, v36, v100
    v_add_f32 v37, v37, v101
    v_add_f32 v38, v38, v102
    v_add_f32 v39, v39, v103
    v_add_f32 v40, v40, v104
    v_add_f32 v41, v41, v105
    v_add_f32 v42, v42, v106
    v_add_f32 v43, v43, v107
    v_add_f32 v44, v44, v108
    v_add_f32 v45, v45, v109
    v_add_f32 v46, v46, v110
    v_add_f32 v47, v47, v111
    v_cvt_pk_bf16_f32 v176, v16, v17
    v_cvt_pk_bf16_f32 v177, v18, v19
    v_cvt_pk_bf16_f32 v178, v20, v21
    v_cvt_pk_bf16_f32 v179, v22, v23
    v_cvt_pk_bf16_f32 v180, v24, v25
    v_cvt_pk_bf16_f32 v181, v26, v27
    v_cvt_pk_bf16_f32 v182, v28, v29
    v_cvt_pk_bf16_f32 v183, v30, v31
    v_cvt_pk_bf16_f32 v184, v32, v33
    v_cvt_pk_bf16_f32 v185, v34, v35
    v_cvt_pk_bf16_f32 v186, v36, v37
    v_cvt_pk_bf16_f32 v187, v38, v39
    v_cvt_pk_bf16_f32 v188, v40, v41
    v_cvt_pk_bf16_f32 v189, v42, v43
    v_cvt_pk_bf16_f32 v190, v44, v45
    v_cvt_pk_bf16_f32 v191, v46, v47
    s_branch concat_heads__gqa_block_cached__mha_block_cached__near_ridge_kernel_p_xout
concat_heads__gqa_block_cached__mha_block_cached__near_ridge_kernel_p_x1:
    v_and_or_b32 v16, v16, v4, s68
    v_and_or_b32 v17, v17, v4, s69
    v_and_or_b32 v18, v18, v4, s70
    v_and_or_b32 v19, v19, v4, s71
    v_and_or_b32 v20, v20, v4, s68
    v_and_or_b32 v21, v21, v4, s69
    v_and_or_b32 v22, v22, v4, s70
    v_and_or_b32 v23, v23, v4, s71
    v_and_or_b32 v24, v24, v4, s68
    v_and_or_b32 v25, v25, v4, s69
    v_and_or_b32 v26, v26, v4, s70
    v_and_or_b32 v27, v27, v4, s71
    v_and_or_b32 v28, v28, v4, s68
    v_and_or_b32 v29, v29, v4, s69
    v_and_or_b32 v30, v30, v4, s70
    v_and_or_b32 v31, v31, v4, s71
    v_and_or_b32 v32, v32, v4, s68
    v_and_or_b32 v33, v33, v4, s69
    v_and_or_b32 v34, v34, v4, s70
    v_and_or_b32 v35, v35, v4, s71
    v_and_or_b32 v36, v36, v4, s68
    v_and_or_b32 v37, v37, v4, s69
    v_and_or_b32 v38, v38, v4, s70
    v_and_or_b32 v39, v39, v4, s71
    v_and_or_b32 v40, v40, v4, s68
    v_and_or_b32 v41, v41, v4, s69
    v_and_or_b32 v42, v42, v4, s70
    v_and_or_b32 v43, v43, v4, s71
    v_and_or_b32 v44, v44, v4, s68
    v_and_or_b32 v45, v45, v4, s69
    v_and_or_b32 v46, v46, v4, s70
    v_and_or_b32 v47, v47, v4, s71
    s_add_u32 s25, s52, 0
    buffer_store_dwordx4 v[16:19], v1, s[60:63], s25 offen offset:0 sc1
    buffer_store_dwordx4 v[20:23], v1, s[60:63], s25 offen offset:1024 sc1
    buffer_store_dwordx4 v[24:27], v1, s[60:63], s25 offen offset:2048 sc1
    buffer_store_dwordx4 v[28:31], v1, s[60:63], s25 offen offset:3072 sc1
    s_add_u32 s25, s25, 4096
    buffer_store_dwordx4 v[32:35], v1, s[60:63], s25 offen offset:0 sc1
    buffer_store_dwordx4 v[36:39], v1, s[60:63], s25 offen offset:1024 sc1
    buffer_store_dwordx4 v[40:43], v1, s[60:63], s25 offen offset:2048 sc1
    buffer_store_dwordx4 v[44:47], v1, s[60:63], s25 offen offset:3072 sc1
concat_heads__gqa_block_cached__mha_block_cached__near_ridge_kernel_p_poll1:
    s_add_u32 s25, s31, 0
    buffer_load_dwordx4 v[80:83], v1, s[60:63], s25 offen offset:0 sc0 sc1
    buffer_load_dwordx4 v[84:87], v1, s[60:63], s25 offen offset:1024 sc0 sc1
    buffer_load_dwordx4 v[88:91], v1, s[60:63], s25 offen offset:2048 sc0 sc1
    buffer_load_dwordx4 v[92:95], v1, s[60:63], s25 offen offset:3072 sc0 sc1
    s_add_u32 s25, s25, 4096
    buffer_load_dwordx4 v[96:99], v1, s[60:63], s25 offen offset:0 sc0 sc1
    buffer_load_dwordx4 v[100:103], v1, s[60:63], s25 offen offset:1024 sc0 sc1
    buffer_load_dwordx4 v[104:107], v1, s[60:63], s25 offen offset:2048 sc0 sc1
    buffer_load_dwordx4 v[108:111], v1, s[60:63], s25 offen offset:3072 sc0 sc1
    s_waitcnt vmcnt(0)
    v_xor_b32 v5, s68, v80
    v_xor_b32 v3, s69, v81
    v_or_b32 v5, v5, v3
    v_xor_b32 v3, s70, v82
    v_or_b32 v5, v5, v3
    v_xor_b32 v3, s71, v83
    v_or_b32 v5, v5, v3
    v_xor_b32 v3, s68, v84
    v_or_b32 v5, v5, v3
    v_xor_b32 v3, s69, v85
    v_or_b32 v5, v5, v3
    v_xor_b32 v3, s70, v86
    v_or_b32 v5, v5, v3
    v_xor_b32 v3, s71, v87
    v_or_b32 v5, v5, v3
    v_xor_b32 v3, s68, v88
    v_or_b32 v5, v5, v3
    v_xor_b32 v3, s69, v89
    v_or_b32 v5, v5, v3
    v_xor_b32 v3, s70, v90
    v_or_b32 v5, v5, v3
    v_xor_b32 v3, s71, v91
    v_or_b32 v5, v5, v3
    v_xor_b32 v3, s68, v92
    v_or_b32 v5, v5, v3
    v_xor_b32 v3, s69, v93
    v_or_b32 v5, v5, v3
    v_xor_b32 v3, s70, v94
    v_or_b32 v5, v5, v3
    v_xor_b32 v3, s71, v95
    v_or_b32 v5, v5, v3
    v_xor_b32 v3, s68, v96
    v_or_b32 v5, v5, v3
    v_xor_b32 v3, s69, v97
    v_or_b32 v5, v5, v3
    v_xor_b32 v3, s70, v98
    v_or_b32 v5, v5, v3
    v_xor_b32 v3, s71, v99
    v_or_b32 v5, v5, v3
    v_xor_b32 v3, s68, v100
    v_or_b32 v5, v5, v3
    v_xor_b32 v3, s69, v101
    v_or_b32 v5, v5, v3
    v_xor_b32 v3, s70, v102
    v_or_b32 v5, v5, v3
    v_xor_b32 v3, s71, v103
    v_or_b32 v5, v5, v3
    v_xor_b32 v3, s68, v104
    v_or_b32 v5, v5, v3
    v_xor_b32 v3, s69, v105
    v_or_b32 v5, v5, v3
    v_xor_b32 v3, s70, v106
    v_or_b32 v5, v5, v3
    v_xor_b32 v3, s71, v107
    v_or_b32 v5, v5, v3
    v_xor_b32 v3, s68, v108
    v_or_b32 v5, v5, v3
    v_xor_b32 v3, s69, v109
    v_or_b32 v5, v5, v3
    v_xor_b32 v3, s70, v110
    v_or_b32 v5, v5, v3
    v_xor_b32 v3, s71, v111
    v_or_b32 v5, v5, v3
    v_and_b32 v5, 0xff, v5
    v_cmp_ne_u32 vcc, 0, v5
    s_nop 3
    s_cmp_eq_u64 vcc, 0
    s_cbranch_scc1 concat_heads__gqa_block_cached__mha_block_cached__near_ridge_kernel_p_got1
    s_sleep 1
    s_branch concat_heads__gqa_block_cached__mha_block_cached__near_ridge_kernel_p_poll1
concat_heads__gqa_block_cached__mha_block_cached__near_ridge_kernel_p_got1:
    v_add_f32 v48, v48, v80
    v_add_f32 v49, v49, v81
    v_add_f32 v50, v50, v82
    v_add_f32 v51, v51, v83
    v_add_f32 v52, v52, v84
    v_add_f32 v53, v53, v85
    v_add_f32 v54, v54, v86
    v_add_f32 v55, v55, v87
    v_add_f32 v56, v56, v88
    v_add_f32 v57, v57, v89
    v_add_f32 v58, v58, v90
    v_add_f32 v59, v59, v91
    v_add_f32 v60, v60, v92
    v_add_f32 v61, v61, v93
    v_add_f32 v62, v62, v94
    v_add_f32 v63, v63, v95
    v_add_f32 v64, v64, v96
    v_add_f32 v65, v65, v97
    v_add_f32 v66, v66, v98
    v_add_f32 v67, v67, v99
    v_add_f32 v68, v68, v100
    v_add_f32 v69, v69, v101
    v_add_f32 v70, v70, v102
    v_add_f32 v71, v71, v103
    v_add_f32 v72, v72, v104
    v_add_f32 v73, v73, v105
    v_add_f32 v74, v74, v106
    v_add_f32 v75, v75, v107
    v_add_f32 v76, v76, v108
    v_add_f32 v77, v77, v109
    v_add_f32 v78, v78, v110
    v_add_f32 v79, v79, v111
    v_cvt_pk_bf16_f32 v176, v48, v49
    v_cvt_pk_bf16_f32 v177, v50, v51
    v_cvt_pk_bf16_f32 v178, v52, v53
    v_cvt_pk_bf16_f32 v179, v54, v55
    v_cvt_pk_bf16_f32 v180, v56, v57
    v_cvt_pk_bf16_f32 v181, v58, v59
    v_cvt_pk_bf16_f32 v182, v60, v61
    v_cvt_pk_bf16_f32 v183, v62, v63
    v_cvt_pk_bf16_f32 v184, v64, v65
    v_cvt_pk_bf16_f32 v185, v66, v67
    v_cvt_pk_bf16_f32 v186, v68, v69
    v_cvt_pk_bf16_f32 v187, v70, v71
    v_cvt_pk_bf16_f32 v188, v72, v73
    v_cvt_pk_bf16_f32 v189, v74, v75
    v_cvt_pk_bf16_f32 v190, v76, v77
    v_cvt_pk_bf16_f32 v191, v78, v79
concat_heads__gqa_block_cached__mha_block_cached__near_ridge_kernel_p_xout:
    s_lshr_b32 s25, s4, 1
    s_lshl_b32 s25, s25, 1
    s_add_u32 s25, s25, s59
    s_lshl_b32 s25, s25, 3
    s_add_u32 s25, s25, s29
    s_lshl_b32 s25, s25, 17
    s_lshl_b32 s26, s28, 11
    s_add_u32 s25, s25, s26
    s_lshl_b32 s26, s30, 1
    s_add_u32 s25, s25, s26
    buffer_store_dwordx4 v[176:179], v6, s[16:19], s25 offen offset:0
    buffer_store_dwordx4 v[180:183], v6, s[16:19], s25 offen offset:32
    buffer_store_dwordx4 v[184:187], v6, s[16:19], s25 offen offset:64
    buffer_store_dwordx4 v[188:191], v6, s[16:19], s25 offen offset:96
    v_mov_b32 v4, 0
    v_mov_b32 v5, s65
    v_cmp_eq_u32 vcc, 0, v0
    s_and_saveexec_b64 s[44:45], vcc
    buffer_store_dword v5, v4, s[60:63], s66 offen sc0 sc1
    s_mov_b64 exec, s[44:45]
    s_and_b32 s97, s30, 0x380
    s_or_b32 s97, s97, s4
    s_cmp_lg_u32 s97, 0
    s_cbranch_scc1 concat_heads__gqa_block_cached__mha_block_cached__near_ridge_kernel_df_d
    s_lshl_b32 s96, s28, 4
    s_lshl_b32 s97, s29, 1
    s_add_u32 s96, s96, s97
    s_add_u32 s96, s96, s59
    s_lshl_b32 s96, s96, 8
    s_add_u32 s96, s96, 55574528
    s_add_u32 s94, s92, s96
    s_addc_u32 s95, s93, 0
concat_heads__gqa_block_cached__mha_block_cached__near_ridge_kernel_df:
    s_load_dwordx8 s[76:83], s[94:95], 32 glc
    s_waitcnt lgkmcnt(0)
    s_xor_b32 s97, s76, s75
    s_xor_b32 s98, s77, s75
    s_or_b32 s97, s97, s98
    s_xor_b32 s98, s78, s75
    s_or_b32 s97, s97, s98
    s_xor_b32 s98, s79, s75
    s_or_b32 s97, s97, s98
    s_xor_b32 s98, s80, s75
    s_or_b32 s97, s97, s98
    s_xor_b32 s98, s81, s75
    s_or_b32 s97, s97, s98
    s_xor_b32 s98, s82, s75
    s_or_b32 s97, s97, s98
    s_xor_b32 s98, s83, s75
    s_or_b32 s97, s97, s98
    s_cmp_eq_u32 s97, 0
    s_cbranch_scc0 concat_heads__gqa_block_cached__mha_block_cached__near_ridge_kernel_df
    v_mov_b32 v4, 0
    v_mov_b32 v5, s75
    v_cmp_eq_u32 vcc, 0, v0
    s_and_saveexec_b64 s[44:45], vcc
    buffer_store_dword v5, v4, s[60:63], s96 offen sc1
    s_mov_b64 exec, s[44:45]
concat_heads__gqa_block_cached__mha_block_cached__near_ridge_kernel_df_d:
    s_waitcnt vmcnt(0)
    s_branch concat_heads__gqa_block_cached__mha_block_cached__near_ridge_kernel_p_fin
concat_heads__gqa_block_cached__mha_block_cached__near_ridge_kernel_p_loader:
    s_setprio 3
    s_sub_u32 s55, s4, 4
    v_lshrrev_b32 v4, 4, v0
    v_and_b32 v5, 15, v0
    v_lshlrev_b32 v12, 2, v4
    v_xor_b32 v12, v12, v5
    v_lshlrev_b32 v12, 4, v12
    v_lshlrev_b32 v4, 11, v4
    v_add_u32 v12, v12, v4
    v_add_u32 v13, 7168, v12
    v_add_u32 v14, 14336, v12
    v_add_u32 v15, 21504, v12
    s_cmp_eq_u32 s28, 0
    s_cselect_b32 s12, s32, s34
    s_cselect_b32 s13, s33, s35
    s_and_b32 s13, s13, 0xffff
    s_mov_b32 s14, 8388608
    s_mov_b32 s15, 0x20000
    s_mov_b32 s8, s38
    s_and_b32 s9, s39, 0xffff
    s_mov_b32 s10, 67108864
    s_mov_b32 s11, 0x20000
    s_lshl_b32 s25, s55, 3
    s_add_u32 s25, s25, s29
    s_lshl_b32 s20, s25, 18
    s_lshl_b32 s25, s28, 23
    s_add_u32 s20, s20, s25
    s_lshl_b32 s25, s59, 17
    s_add_u32 s20, s20, s25
    s_lshl_b32 s21, s55, 16
    s_lshl_b32 s25, s30, 1
    s_add_u32 s21, s21, s25
    s_lshl_b32 s25, s59, 22
    s_add_u32 s21, s21, s25
    s_lshl_b32 s53, s55, 12
    s_lshl_b32 s54, s55, 13
    s_add_u32 s54, s54, 65536
    s_cmp_eq_u32 s43, 0
    s_mov_b32 s68, 0x86534210
    s_mov_b32 s69, 0xfedbca97
    s_cmp_eq_u32 s43, 1
    s_cselect_b32 s68, 0x76453201, s68
    s_cselect_b32 s69, 0xfecdba89, s69
    s_cmp_eq_u32 s43, 2
    s_cselect_b32 s68, 0x75643120, s68
    s_cselect_b32 s69, 0xfdecb9a8, s69
    s_cmp_eq_u32 s43, 3
    s_cselect_b32 s68, 0x67542310, s68
    s_cselect_b32 s69, 0xefdcab98, s69
    s_mov_b64 s[70:71], s[68:69]
    s_mov_b32 s22, 0
    s_mov_b32 s58, 0
    s_and_b32 s25, s70, 15
    s_lshr_b64 s[70:71], s[70:71], 4
    s_lshl_b32 s25, s25, 18
    s_add_u32 m0, s58, s54
    s_add_u32 s52, s21, s25
    buffer_load_dwordx4 v12, s[12:15], s52 offen offset:0  lds
    buffer_load_dwordx4 v13, s[12:15], s52 offen offset:1024  lds
    buffer_load_dwordx4 v14, s[12:15], s52 offen offset:2048  lds
    buffer_load_dwordx4 v15, s[12:15], s52 offen offset:3072  lds
    s_add_u32 m0, m0, 4096
    s_add_u32 s52, s52, 32768
    buffer_load_dwordx4 v12, s[12:15], s52 offen offset:0  lds
    buffer_load_dwordx4 v13, s[12:15], s52 offen offset:1024  lds
    buffer_load_dwordx4 v14, s[12:15], s52 offen offset:2048  lds
    buffer_load_dwordx4 v15, s[12:15], s52 offen offset:3072  lds
    s_add_u32 s58, s58, 32768
    s_cmp_eq_u32 s58, 98304
    s_cselect_b32 s58, 0, s58
    s_and_b32 s25, s70, 15
    s_lshr_b64 s[70:71], s[70:71], 4
    s_lshl_b32 s25, s25, 18
    s_add_u32 m0, s58, s54
    s_add_u32 s52, s21, s25
    buffer_load_dwordx4 v12, s[12:15], s52 offen offset:0  lds
    buffer_load_dwordx4 v13, s[12:15], s52 offen offset:1024  lds
    buffer_load_dwordx4 v14, s[12:15], s52 offen offset:2048  lds
    buffer_load_dwordx4 v15, s[12:15], s52 offen offset:3072  lds
    s_add_u32 m0, m0, 4096
    s_add_u32 s52, s52, 32768
    buffer_load_dwordx4 v12, s[12:15], s52 offen offset:0  lds
    buffer_load_dwordx4 v13, s[12:15], s52 offen offset:1024  lds
    buffer_load_dwordx4 v14, s[12:15], s52 offen offset:2048  lds
    buffer_load_dwordx4 v15, s[12:15], s52 offen offset:3072  lds
    s_add_u32 s58, s58, 32768
    s_cmp_eq_u32 s58, 98304
    s_cselect_b32 s58, 0, s58
    s_cmp_lg_u32 s55, 0
    s_cbranch_scc1 concat_heads__gqa_block_cached__mha_block_cached__near_ridge_kernel_dw_d
    s_lshl_b32 s96, s28, 4
    s_lshl_b32 s97, s29, 1
    s_add_u32 s96, s96, s97
    s_add_u32 s96, s96, s59
    s_lshl_b32 s96, s96, 8
    s_add_u32 s96, s96, 55574528
    s_add_u32 s94, s92, s96
    s_addc_u32 s95, s93, 0
    v_and_b32 v4, 15, v0
    v_lshlrev_b32 v4, 2, v4
concat_heads__gqa_block_cached__mha_block_cached__near_ridge_kernel_dw:
    buffer_load_dword v5, v4, s[8:11], s96 offen offset:64 sc1
    s_waitcnt vmcnt(0)
    v_cmp_ne_u32 vcc, s75, v5
    s_nop 3
    s_cmp_eq_u64 vcc, 0
    s_cbranch_scc1 concat_heads__gqa_block_cached__mha_block_cached__near_ridge_kernel_dw_d
concat_heads__gqa_block_cached__mha_block_cached__near_ridge_kernel_dw_z:
    s_sleep 1
    s_branch concat_heads__gqa_block_cached__mha_block_cached__near_ridge_kernel_dw
concat_heads__gqa_block_cached__mha_block_cached__near_ridge_kernel_dw_d:
    s_barrier
    s_and_b32 s25, s68, 15
    s_lshr_b64 s[68:69], s[68:69], 4
    s_lshl_b32 s25, s25, 13
    s_add_u32 s31, s20, s25
    s_add_u32 m0, s22, s53
    s_nop 0
    buffer_load_dwordx4 v1, s[8:11], s31 offen offset:0 sc1 lds
    buffer_load_dwordx4 v1, s[8:11], s31 offen offset:1024 sc1 lds
    buffer_load_dwordx4 v1, s[8:11], s31 offen offset:2048 sc1 lds
    buffer_load_dwordx4 v1, s[8:11], s31 offen offset:3072 sc1 lds
    s_add_u32 s22, s22, 16384
    s_and_b32 s22, s22, 65535
    s_add_u32 m0, s22, s53
    s_add_u32 s31, s31, 4096
    buffer_load_dwordx4 v1, s[8:11], s31 offen offset:0 sc1 lds
    buffer_load_dwordx4 v1, s[8:11], s31 offen offset:1024 sc1 lds
    buffer_load_dwordx4 v1, s[8:11], s31 offen offset:2048 sc1 lds
    buffer_load_dwordx4 v1, s[8:11], s31 offen offset:3072 sc1 lds
    s_add_u32 s22, s22, 16384
    s_and_b32 s22, s22, 65535
    s_waitcnt vmcnt(0)
    s_mov_b32 s24, 0
concat_heads__gqa_block_cached__mha_block_cached__near_ridge_kernel_p_lloop:
    s_waitcnt vmcnt(12)
    s_barrier
    s_and_b32 s25, s68, 15
    s_lshr_b64 s[68:69], s[68:69], 4
    s_lshl_b32 s25, s25, 13
    s_add_u32 s31, s20, s25
    s_add_u32 m0, s22, s53
    s_nop 0
    buffer_load_dwordx4 v1, s[8:11], s31 offen offset:0 sc1 lds
    buffer_load_dwordx4 v1, s[8:11], s31 offen offset:1024 sc1 lds
    buffer_load_dwordx4 v1, s[8:11], s31 offen offset:2048 sc1 lds
    buffer_load_dwordx4 v1, s[8:11], s31 offen offset:3072 sc1 lds
    s_add_u32 s22, s22, 16384
    s_and_b32 s22, s22, 65535
    s_waitcnt vmcnt(12)
    s_barrier
    s_add_u32 m0, s22, s53
    s_add_u32 s31, s31, 4096
    buffer_load_dwordx4 v1, s[8:11], s31 offen offset:0 sc1 lds
    buffer_load_dwordx4 v1, s[8:11], s31 offen offset:1024 sc1 lds
    buffer_load_dwordx4 v1, s[8:11], s31 offen offset:2048 sc1 lds
    buffer_load_dwordx4 v1, s[8:11], s31 offen offset:3072 sc1 lds
    s_add_u32 s22, s22, 16384
    s_and_b32 s22, s22, 65535
    s_and_b32 s25, s70, 15
    s_lshr_b64 s[70:71], s[70:71], 4
    s_lshl_b32 s25, s25, 18
    s_add_u32 m0, s58, s54
    s_add_u32 s52, s21, s25
    buffer_load_dwordx4 v12, s[12:15], s52 offen offset:0  lds
    buffer_load_dwordx4 v13, s[12:15], s52 offen offset:1024  lds
    buffer_load_dwordx4 v14, s[12:15], s52 offen offset:2048  lds
    buffer_load_dwordx4 v15, s[12:15], s52 offen offset:3072  lds
    s_add_u32 m0, m0, 4096
    s_add_u32 s52, s52, 32768
    buffer_load_dwordx4 v12, s[12:15], s52 offen offset:0  lds
    buffer_load_dwordx4 v13, s[12:15], s52 offen offset:1024  lds
    buffer_load_dwordx4 v14, s[12:15], s52 offen offset:2048  lds
    buffer_load_dwordx4 v15, s[12:15], s52 offen offset:3072  lds
    s_add_u32 s58, s58, 32768
    s_cmp_eq_u32 s58, 98304
    s_cselect_b32 s58, 0, s58
    s_add_u32 s24, s24, 1
    s_cmp_lt_u32 s24, 14
    s_cbranch_scc1 concat_heads__gqa_block_cached__mha_block_cached__near_ridge_kernel_p_lloop
    s_waitcnt vmcnt(12)
    s_barrier
    s_and_b32 s25, s68, 15
    s_lshr_b64 s[68:69], s[68:69], 4
    s_lshl_b32 s25, s25, 13
    s_add_u32 s31, s20, s25
    s_add_u32 m0, s22, s53
    s_nop 0
    buffer_load_dwordx4 v1, s[8:11], s31 offen offset:0 sc1 lds
    buffer_load_dwordx4 v1, s[8:11], s31 offen offset:1024 sc1 lds
    buffer_load_dwordx4 v1, s[8:11], s31 offen offset:2048 sc1 lds
    buffer_load_dwordx4 v1, s[8:11], s31 offen offset:3072 sc1 lds
    s_add_u32 s22, s22, 16384
    s_and_b32 s22, s22, 65535
    s_waitcnt vmcnt(12)
    s_barrier
    s_add_u32 m0, s22, s53
    s_add_u32 s31, s31, 4096
    buffer_load_dwordx4 v1, s[8:11], s31 offen offset:0 sc1 lds
    buffer_load_dwordx4 v1, s[8:11], s31 offen offset:1024 sc1 lds
    buffer_load_dwordx4 v1, s[8:11], s31 offen offset:2048 sc1 lds
    buffer_load_dwordx4 v1, s[8:11], s31 offen offset:3072 sc1 lds
    s_add_u32 s22, s22, 16384
    s_and_b32 s22, s22, 65535
    s_waitcnt vmcnt(4)
    s_barrier
    s_waitcnt vmcnt(0)
    s_barrier
concat_heads__gqa_block_cached__mha_block_cached__near_ridge_kernel_p_fin:
    s_waitcnt vmcnt(0)
concat_heads__gqa_block_cached__mha_block_cached__near_ridge_kernel_done:
    s_endpgm
.section .rodata,"a"
.p2align 6
.amdhsa_kernel concat_heads__gqa_block_cached__mha_block_cached__near_ridge_kernel
  .amdhsa_next_free_vgpr 256
  .amdhsa_next_free_sgpr 102
  .amdhsa_accum_offset 256
  .amdhsa_group_segment_fixed_size 0
  .amdhsa_kernarg_size 104
  .amdhsa_user_sgpr_count 2
  .amdhsa_user_sgpr_kernarg_segment_ptr 1
  .amdhsa_system_sgpr_workgroup_id_x 1
  .amdhsa_float_denorm_mode_32 3
  .amdhsa_float_denorm_mode_16_64 3
.end_amdhsa_kernel
```
